```python
import torch

def _softmax(x, axis=-1):
    return torch.softmax(x, dim=axis)

def _gelu(x):
    return torch.nn.functional.gelu(x, approximate='tanh')

def _silu(x):
    return torch.nn.functional.silu(x)

def _sigmoid(x):
    return torch.sigmoid(x)

def _layernorm(x, axis=-1, eps=1e-05):
    m = x.mean(dim=axis, keepdim=True)
    v = x.var(dim=axis, keepdim=True, unbiased=False)
    return (x - m) / torch.sqrt(v + eps)

def _scatter_add(tgt, idx, src, axis=0):
    return tgt.clone().index_add_(axis, idx, src)

def _segment_sum(src, seg, n):
    out = torch.zeros((n,) + src.shape[1:], dtype=src.dtype)
    return out.index_add_(0, seg, src)

def _pad(x, pw):
    flat = tuple((v for pair in reversed(pw) for v in pair))
    return torch.nn.functional.pad(x, flat)
kernel_name = 'recurrent_scan__softmax_full_mha__mixer_gmlp__prompt'

def setup_inputs():

    _w = lambda a: (lambda t: t.to(torch.bfloat16) if t.is_floating_point() else t)(torch.as_tensor(a))

    def _A_setup():
        B, S, D = (1, 2048, 512)
        return {'x': _w((lambda *s: torch.randn(*s, dtype=torch.bfloat16) * 0.05)(B, S, D)), 'wqkv': _w((lambda *s: torch.randn(*s, dtype=torch.bfloat16) * 0.05)(D, 3 * D)), 'wo': _w((lambda *s: torch.randn(*s, dtype=torch.bfloat16) * 0.05)(D, D))}
    _A_in = _A_setup()

    def _B_setup():
        B, S, D, F = (1, 2048, 512, 1792)
        Fh = F // 2
        return {'x': _w((lambda *s: torch.randn(*s, dtype=torch.bfloat16) * 0.05)(B, S, D)), 'w_in': _w((lambda *s: torch.randn(*s, dtype=torch.bfloat16) * 0.8)(D, 2 * Fh)), 'w_sp': _w(0.01 * (lambda *s: torch.randn(*s, dtype=torch.bfloat16) * 0.8)(S, S)), 'b_sp': _w(1.0 + 0.01 * (lambda *s: torch.randn(*s, dtype=torch.bfloat16) * 0.05)(S)), 'w_out': _w((lambda *s: torch.randn(*s, dtype=torch.bfloat16) * 0.05)(Fh, D))}
    _B_in = _B_setup()
    return {'A_x': _A_in['x'], 'A_wqkv': _A_in['wqkv'], 'A_wo': _A_in['wo'], 'B_x': _B_in['x'], 'B_w_in': _B_in['w_in'], 'B_w_sp': _B_in['w_sp'], 'B_b_sp': _B_in['b_sp'], 'B_w_out': _B_in['w_out']}

def reference(A_x, A_wqkv, A_wo, B_x, B_w_in, B_w_sp, B_b_sp, B_w_out):

    def _A_ref(x, wqkv, wo):
        B, S, D = x.shape
        H = 32
        Dh = D // H
        qkv = (lambda x, *d: x.permute(*d))((x @ wqkv).reshape(B, S, 3, H, Dh), 2, 0, 3, 1, 4)
        q, k, v = (qkv[0], qkv[1], qkv[2])
        scale = Dh ** (-0.5)
        scores = torch.einsum('bhqd,bhkd->bhqk', q, k) * scale
        p = _softmax(scores, axis=-1)
        o = torch.einsum('bhqk,bhkd->bhqd', p, v)
        return (lambda x, *d: x.permute(*d))(o, 0, 2, 1, 3).reshape(B, S, D) @ wo

    def _B_ref(x, w_in, w_sp, b_sp, w_out):
        B, S, D = x.shape
        F = w_in.shape[-1]
        Fh = F // 2
        z = _gelu(torch.einsum('bsd,df->bsf', x, w_in))
        z1 = z[..., :Fh].clone()
        z2 = _layernorm(z[..., Fh:], axis=-1)
        g = torch.einsum('ts,bsf->btf', w_sp, z2) + b_sp[None, :, None]
        return torch.einsum('bsf,fd->bsd', z1 * g, w_out)
    x = A_x
    xn = _layernorm(x, axis=-1)
    s = _A_ref(xn, A_wqkv, A_wo)
    g = _silu(_B_ref(xn, B_w_in, B_w_sp, B_b_sp, B_w_out))
    return x + s * g
```

```asm
; @launch grid=(512,1,1) block=(512,1,1) lds=81920
.amdgcn_target "amdgcn-amd-amdhsa--gfx950"
.text
.globl recurrent_scan__softmax_full_mha__mixer_gmlp__prompt_kernel
.p2align 8
.type recurrent_scan__softmax_full_mha__mixer_gmlp__prompt_kernel,@function
recurrent_scan__softmax_full_mha__mixer_gmlp__prompt_kernel:
  s_cmp_ge_u32 s2, 512
  s_cbranch_scc1 L_exit
  s_and_b32 s3, s2, 255
  s_mov_b32 s4, 0
  s_cmp_ge_u32 s2, 256
  s_cbranch_scc1 L_role_g
  s_load_dwordx2 s[8:9], s[0:1], 80
  s_load_dwordx2 s[10:11], s[0:1], 0
  s_load_dwordx2 s[12:13], s[0:1], 8
  v_lshrrev_b32 v16, 6, v0
  v_and_b32 v1, 63, v0
  v_readfirstlane_b32 s32, v16
  s_lshr_b32 s37, s3, 3
  s_and_b32 s36, s3, 1
  s_lshl_b32 s33, s36, 3
  s_and_b32 s38, s37, 7
  s_add_u32 s33, s33, s38
  s_lshl_b32 s34, s3, 1
  s_and_b32 s34, s34, 12
  s_lshr_b32 s38, s37, 3
  s_add_u32 s34, s34, s38
  s_lshl_b32 s43, s34, 7
  s_lshl_b32 s44, s34, 6
  s_add_u32 s44, s44, 2048
  s_cmp_lt_u32 s32, 4
  s_cbranch_scc1 L_Q_comp
  s_cmp_ge_u32 s32, 6
  s_cbranch_scc1 L_Q_aux
  s_setprio 3
  s_sub_u32 s45, s32, 4
  v_lshrrev_b32 v16, 3, v1
  v_and_b32 v17, 7, v1
  v_lshrrev_b32 v18, 4, v1
  v_xor_b32 v18, v17, v18
  v_lshlrev_b32 v18, 4, v18
  v_lshl_add_u32 v48, v16, 10, v18
  v_xor_b32 v49, 64, v48
  v_bfe_u32 v19, v1, 4, 1
  v_lshlrev_b32 v18, 2, v19
  v_xor_b32 v18, v18, v17
  v_lshlrev_b32 v18, 4, v18
  v_mul_u32_u24 v50, 3072, v16
  v_add_u32 v50, v50, v18
  v_xor_b32 v51, 32, v50
  v_lshlrev_b32 v18, 1, v19
  v_and_b32 v20, 3, v1
  v_xor_b32 v18, v18, v20
  v_lshlrev_b32 v18, 4, v18
  v_bfe_u32 v21, v1, 5, 1
  v_bfe_u32 v22, v1, 3, 1
  v_lshlrev_b32 v16, 3, v22
  v_lshl_add_u32 v16, v21, 2, v16
  v_bfe_u32 v20, v1, 2, 1
  v_lshl_add_u32 v16, v20, 1, v16
  v_add_u32 v16, v16, v19
  v_mul_u32_u24 v52, 3072, v16
  v_add_u32 v52, v52, v18
  s_lshl_b32 s46, s33, 17
  s_lshl_b32 s37, s45, 16
  s_add_u32 s46, s46, s37
  s_lshl_b32 s52, s45, 13
  s_mul_i32 s53, s45, 7168
  s_add_u32 s53, s53, 49152
  s_mul_i32 s47, s45, 98304
  s_lshl_b32 s48, s34, 1
  s_add_u32 s48, s48, s33
  s_add_u32 s48, s48, 0
  s_and_b32 s48, s48, 7
  s_waitcnt lgkmcnt(0)
  s_mov_b32 s20, s10
  s_and_b32 s21, s11, 0xffff
  s_mov_b32 s22, 2097152
  s_mov_b32 s23, 0x20000
  s_mov_b32 s24, s12
  s_and_b32 s25, s13, 0xffff
  s_mov_b32 s26, 1572864
  s_mov_b32 s27, 0x20000
  s_mov_b32 s16, s8
  s_and_b32 s17, s9, 0xffff
  s_mov_b32 s18, 33554432
  s_mov_b32 s19, 0x20000
  s_add_u32 s14, s8, 21757952
  s_addc_u32 s15, s9, 0
  s_load_dword s4, s[14:15], 0
  s_mov_b32 s54, s48
  s_mov_b32 s55, s52
  s_mul_i32 s50, s48, 196608
  s_add_u32 s50, s50, s47
  s_add_u32 s51, s50, s44
  s_add_u32 s50, s50, s43
  s_add_u32 s48, s48, 1
  s_and_b32 s48, s48, 7
  s_add_u32 m0, s53, 0
  s_add_u32 s39, s50, 0
  buffer_load_dwordx4 v50, s[24:27], s39 offen lds
  s_add_u32 m0, s53, 1024
  s_add_u32 s39, s50, 24576
  buffer_load_dwordx4 v51, s[24:27], s39 offen lds
  s_add_u32 m0, s53, 2048
  s_add_u32 s39, s50, 49152
  buffer_load_dwordx4 v50, s[24:27], s39 offen lds
  s_add_u32 m0, s53, 3072
  s_add_u32 s39, s50, 73728
  buffer_load_dwordx4 v51, s[24:27], s39 offen lds
  s_add_u32 m0, s53, 4096
  s_add_u32 s39, s51, 0
  buffer_load_dwordx4 v52, s[24:27], s39 offen lds
  s_add_u32 m0, s53, 5120
  s_add_u32 s39, s51, 49152
  buffer_load_dwordx4 v52, s[24:27], s39 offen lds
  s_lshl_b32 s49, s54, 7
  s_add_u32 s49, s49, s46
  s_add_u32 s54, s54, 1
  s_and_b32 s54, s54, 7
  s_add_u32 m0, s55, 0
  s_add_u32 s39, s49, 0
  buffer_load_dwordx4 v48, s[20:23], s39 offen lds
  s_add_u32 m0, s55, 1024
  s_add_u32 s39, s49, 8192
  buffer_load_dwordx4 v49, s[20:23], s39 offen lds
  s_add_u32 m0, s55, 2048
  s_add_u32 s39, s49, 16384
  buffer_load_dwordx4 v48, s[20:23], s39 offen lds
  s_add_u32 m0, s55, 3072
  s_add_u32 s39, s49, 24576
  buffer_load_dwordx4 v49, s[20:23], s39 offen lds
  s_add_u32 m0, s55, 4096
  s_add_u32 s39, s49, 32768
  buffer_load_dwordx4 v48, s[20:23], s39 offen lds
  s_add_u32 m0, s55, 5120
  s_add_u32 s39, s49, 40960
  buffer_load_dwordx4 v49, s[20:23], s39 offen lds
  s_add_u32 m0, s55, 6144
  s_add_u32 s39, s49, 49152
  buffer_load_dwordx4 v48, s[20:23], s39 offen lds
  s_add_u32 m0, s55, 7168
  s_add_u32 s39, s49, 57344
  buffer_load_dwordx4 v49, s[20:23], s39 offen lds
  s_add_u32 s55, s55, 16384
  s_cmp_ge_u32 s55, 49152
  s_cselect_b32 s55, s52, s55
  s_mul_i32 s50, s48, 196608
  s_add_u32 s50, s50, s47
  s_add_u32 s51, s50, s44
  s_add_u32 s50, s50, s43
  s_add_u32 s48, s48, 1
  s_and_b32 s48, s48, 7
  s_add_u32 m0, s53, 14336
  s_add_u32 s39, s50, 0
  buffer_load_dwordx4 v50, s[24:27], s39 offen lds
  s_add_u32 m0, s53, 15360
  s_add_u32 s39, s50, 24576
  buffer_load_dwordx4 v51, s[24:27], s39 offen lds
  s_add_u32 m0, s53, 16384
  s_add_u32 s39, s50, 49152
  buffer_load_dwordx4 v50, s[24:27], s39 offen lds
  s_add_u32 m0, s53, 17408
  s_add_u32 s39, s50, 73728
  buffer_load_dwordx4 v51, s[24:27], s39 offen lds
  s_add_u32 m0, s53, 18432
  s_add_u32 s39, s51, 0
  buffer_load_dwordx4 v52, s[24:27], s39 offen lds
  s_add_u32 m0, s53, 19456
  s_add_u32 s39, s51, 49152
  buffer_load_dwordx4 v52, s[24:27], s39 offen lds
  s_lshl_b32 s49, s54, 7
  s_add_u32 s49, s49, s46
  s_add_u32 s54, s54, 1
  s_and_b32 s54, s54, 7
  s_add_u32 m0, s55, 0
  s_add_u32 s39, s49, 0
  buffer_load_dwordx4 v48, s[20:23], s39 offen lds
  s_add_u32 m0, s55, 1024
  s_add_u32 s39, s49, 8192
  buffer_load_dwordx4 v49, s[20:23], s39 offen lds
  s_add_u32 m0, s55, 2048
  s_add_u32 s39, s49, 16384
  buffer_load_dwordx4 v48, s[20:23], s39 offen lds
  s_add_u32 m0, s55, 3072
  s_add_u32 s39, s49, 24576
  buffer_load_dwordx4 v49, s[20:23], s39 offen lds
  s_add_u32 m0, s55, 4096
  s_add_u32 s39, s49, 32768
  buffer_load_dwordx4 v48, s[20:23], s39 offen lds
  s_add_u32 m0, s55, 5120
  s_add_u32 s39, s49, 40960
  buffer_load_dwordx4 v49, s[20:23], s39 offen lds
  s_add_u32 m0, s55, 6144
  s_add_u32 s39, s49, 49152
  buffer_load_dwordx4 v48, s[20:23], s39 offen lds
  s_add_u32 m0, s55, 7168
  s_add_u32 s39, s49, 57344
  buffer_load_dwordx4 v49, s[20:23], s39 offen lds
  s_add_u32 s55, s55, 16384
  s_cmp_ge_u32 s55, 49152
  s_cselect_b32 s55, s52, s55
  s_waitcnt lgkmcnt(0)
  s_mul_i32 s4, s4, 0x9e3779b1
  s_add_u32 s4, s4, 0x7f4a7c15
  s_waitcnt vmcnt(14)
  s_barrier
  s_lshl_b32 s49, s54, 7
  s_add_u32 s49, s49, s46
  s_add_u32 s54, s54, 1
  s_and_b32 s54, s54, 7
  s_add_u32 m0, s55, 0
  s_add_u32 s39, s49, 0
  buffer_load_dwordx4 v48, s[20:23], s39 offen lds
  s_add_u32 m0, s55, 1024
  s_add_u32 s39, s49, 8192
  buffer_load_dwordx4 v49, s[20:23], s39 offen lds
  s_add_u32 m0, s55, 2048
  s_add_u32 s39, s49, 16384
  buffer_load_dwordx4 v48, s[20:23], s39 offen lds
  s_add_u32 m0, s55, 3072
  s_add_u32 s39, s49, 24576
  buffer_load_dwordx4 v49, s[20:23], s39 offen lds
  s_add_u32 m0, s55, 4096
  s_add_u32 s39, s49, 32768
  buffer_load_dwordx4 v48, s[20:23], s39 offen lds
  s_add_u32 m0, s55, 5120
  s_add_u32 s39, s49, 40960
  buffer_load_dwordx4 v49, s[20:23], s39 offen lds
  s_add_u32 m0, s55, 6144
  s_add_u32 s39, s49, 49152
  buffer_load_dwordx4 v48, s[20:23], s39 offen lds
  s_add_u32 m0, s55, 7168
  s_add_u32 s39, s49, 57344
  buffer_load_dwordx4 v49, s[20:23], s39 offen lds
  s_add_u32 s55, s55, 16384
  s_cmp_ge_u32 s55, 49152
  s_cselect_b32 s55, s52, s55
  s_mov_b32 s42, 0
L_Q_ll:
  s_waitcnt vmcnt(8)
  s_barrier
  s_mul_i32 s50, s48, 196608
  s_add_u32 s50, s50, s47
  s_add_u32 s51, s50, s44
  s_add_u32 s50, s50, s43
  s_add_u32 s48, s48, 1
  s_and_b32 s48, s48, 7
  s_add_u32 m0, s53, 0
  s_add_u32 s39, s50, 0
  buffer_load_dwordx4 v50, s[24:27], s39 offen lds
  s_add_u32 m0, s53, 1024
  s_add_u32 s39, s50, 24576
  buffer_load_dwordx4 v51, s[24:27], s39 offen lds
  s_add_u32 m0, s53, 2048
  s_add_u32 s39, s50, 49152
  buffer_load_dwordx4 v50, s[24:27], s39 offen lds
  s_add_u32 m0, s53, 3072
  s_add_u32 s39, s50, 73728
  buffer_load_dwordx4 v51, s[24:27], s39 offen lds
  s_add_u32 m0, s53, 4096
  s_add_u32 s39, s51, 0
  buffer_load_dwordx4 v52, s[24:27], s39 offen lds
  s_add_u32 m0, s53, 5120
  s_add_u32 s39, s51, 49152
  buffer_load_dwordx4 v52, s[24:27], s39 offen lds
  s_lshl_b32 s49, s54, 7
  s_add_u32 s49, s49, s46
  s_add_u32 s54, s54, 1
  s_and_b32 s54, s54, 7
  s_add_u32 m0, s55, 0
  s_add_u32 s39, s49, 0
  buffer_load_dwordx4 v48, s[20:23], s39 offen lds
  s_add_u32 m0, s55, 1024
  s_add_u32 s39, s49, 8192
  buffer_load_dwordx4 v49, s[20:23], s39 offen lds
  s_add_u32 m0, s55, 2048
  s_add_u32 s39, s49, 16384
  buffer_load_dwordx4 v48, s[20:23], s39 offen lds
  s_add_u32 m0, s55, 3072
  s_add_u32 s39, s49, 24576
  buffer_load_dwordx4 v49, s[20:23], s39 offen lds
  s_add_u32 m0, s55, 4096
  s_add_u32 s39, s49, 32768
  buffer_load_dwordx4 v48, s[20:23], s39 offen lds
  s_add_u32 m0, s55, 5120
  s_add_u32 s39, s49, 40960
  buffer_load_dwordx4 v49, s[20:23], s39 offen lds
  s_add_u32 m0, s55, 6144
  s_add_u32 s39, s49, 49152
  buffer_load_dwordx4 v48, s[20:23], s39 offen lds
  s_add_u32 m0, s55, 7168
  s_add_u32 s39, s49, 57344
  buffer_load_dwordx4 v49, s[20:23], s39 offen lds
  s_add_u32 s55, s55, 16384
  s_cmp_ge_u32 s55, 49152
  s_cselect_b32 s55, s52, s55
  s_waitcnt vmcnt(8)
  s_barrier
  s_mul_i32 s50, s48, 196608
  s_add_u32 s50, s50, s47
  s_add_u32 s51, s50, s44
  s_add_u32 s50, s50, s43
  s_add_u32 s48, s48, 1
  s_and_b32 s48, s48, 7
  s_add_u32 m0, s53, 14336
  s_add_u32 s39, s50, 0
  buffer_load_dwordx4 v50, s[24:27], s39 offen lds
  s_add_u32 m0, s53, 15360
  s_add_u32 s39, s50, 24576
  buffer_load_dwordx4 v51, s[24:27], s39 offen lds
  s_add_u32 m0, s53, 16384
  s_add_u32 s39, s50, 49152
  buffer_load_dwordx4 v50, s[24:27], s39 offen lds
  s_add_u32 m0, s53, 17408
  s_add_u32 s39, s50, 73728
  buffer_load_dwordx4 v51, s[24:27], s39 offen lds
  s_add_u32 m0, s53, 18432
  s_add_u32 s39, s51, 0
  buffer_load_dwordx4 v52, s[24:27], s39 offen lds
  s_add_u32 m0, s53, 19456
  s_add_u32 s39, s51, 49152
  buffer_load_dwordx4 v52, s[24:27], s39 offen lds
  s_cmp_eq_u32 s42, 2
  s_cbranch_scc1 L_Q_lle
  s_lshl_b32 s49, s54, 7
  s_add_u32 s49, s49, s46
  s_add_u32 s54, s54, 1
  s_and_b32 s54, s54, 7
  s_add_u32 m0, s55, 0
  s_add_u32 s39, s49, 0
  buffer_load_dwordx4 v48, s[20:23], s39 offen lds
  s_add_u32 m0, s55, 1024
  s_add_u32 s39, s49, 8192
  buffer_load_dwordx4 v49, s[20:23], s39 offen lds
  s_add_u32 m0, s55, 2048
  s_add_u32 s39, s49, 16384
  buffer_load_dwordx4 v48, s[20:23], s39 offen lds
  s_add_u32 m0, s55, 3072
  s_add_u32 s39, s49, 24576
  buffer_load_dwordx4 v49, s[20:23], s39 offen lds
  s_add_u32 m0, s55, 4096
  s_add_u32 s39, s49, 32768
  buffer_load_dwordx4 v48, s[20:23], s39 offen lds
  s_add_u32 m0, s55, 5120
  s_add_u32 s39, s49, 40960
  buffer_load_dwordx4 v49, s[20:23], s39 offen lds
  s_add_u32 m0, s55, 6144
  s_add_u32 s39, s49, 49152
  buffer_load_dwordx4 v48, s[20:23], s39 offen lds
  s_add_u32 m0, s55, 7168
  s_add_u32 s39, s49, 57344
  buffer_load_dwordx4 v49, s[20:23], s39 offen lds
  s_add_u32 s55, s55, 16384
  s_cmp_ge_u32 s55, 49152
  s_cselect_b32 s55, s52, s55
  s_add_u32 s42, s42, 1
  s_branch L_Q_ll
L_Q_lle:
  s_waitcnt vmcnt(0)
  s_barrier
  s_setprio 3
  s_branch L_Q_hb1
L_Q_aux:
  s_waitcnt lgkmcnt(0)
  s_mov_b32 s20, s10
  s_and_b32 s21, s11, 0xffff
  s_mov_b32 s22, 2097152
  s_mov_b32 s23, 0x20000
  s_mov_b32 s24, s12
  s_and_b32 s25, s13, 0xffff
  s_mov_b32 s26, 1572864
  s_mov_b32 s27, 0x20000
  s_mov_b32 s16, s8
  s_and_b32 s17, s9, 0xffff
  s_mov_b32 s18, 33554432
  s_mov_b32 s19, 0x20000
  s_add_u32 s14, s8, 21757952
  s_addc_u32 s15, s9, 0
  s_load_dword s4, s[14:15], 0
  s_sub_u32 s45, s32, 4
  s_lshl_b32 s36, s33, 7
  s_lshl_b32 s37, s34, 3
  s_add_u32 s36, s36, s37
  s_sub_u32 s37, s32, 6
  s_lshl_b32 s37, s37, 2
  s_add_u32 s46, s36, s37
  s_lshl_b32 s36, s46, 10
  v_lshrrev_b32 v16, 4, v1
  v_and_b32 v17, 15, v1
  v_lshlrev_b32 v18, 10, v16
  v_lshl_add_u32 v18, v17, 4, v18
  buffer_load_dwordx4 v[56:59], v18, s[20:23], s36 offen offset:0
  buffer_load_dwordx4 v[60:63], v18, s[20:23], s36 offen offset:256
  buffer_load_dwordx4 v[64:67], v18, s[20:23], s36 offen offset:512
  buffer_load_dwordx4 v[68:71], v18, s[20:23], s36 offen offset:768
  s_waitcnt lgkmcnt(0)
  s_mul_i32 s4, s4, 0x9e3779b1
  s_add_u32 s4, s4, 0x7f4a7c15
  s_waitcnt vmcnt(0)
  v_lshlrev_b32 v72, 16, v56
  v_and_b32 v73, 0xffff0000, v56
  v_lshlrev_b32 v74, 16, v57
  v_and_b32 v75, 0xffff0000, v57
  v_lshlrev_b32 v76, 16, v58
  v_and_b32 v77, 0xffff0000, v58
  v_lshlrev_b32 v78, 16, v59
  v_and_b32 v79, 0xffff0000, v59
  v_lshlrev_b32 v80, 16, v60
  v_and_b32 v81, 0xffff0000, v60
  v_lshlrev_b32 v82, 16, v61
  v_and_b32 v83, 0xffff0000, v61
  v_lshlrev_b32 v84, 16, v62
  v_and_b32 v85, 0xffff0000, v62
  v_lshlrev_b32 v86, 16, v63
  v_and_b32 v87, 0xffff0000, v63
  v_lshlrev_b32 v88, 16, v64
  v_and_b32 v89, 0xffff0000, v64
  v_lshlrev_b32 v90, 16, v65
  v_and_b32 v91, 0xffff0000, v65
  v_lshlrev_b32 v92, 16, v66
  v_and_b32 v93, 0xffff0000, v66
  v_lshlrev_b32 v94, 16, v67
  v_and_b32 v95, 0xffff0000, v67
  v_lshlrev_b32 v96, 16, v68
  v_and_b32 v97, 0xffff0000, v68
  v_lshlrev_b32 v98, 16, v69
  v_and_b32 v99, 0xffff0000, v69
  v_lshlrev_b32 v100, 16, v70
  v_and_b32 v101, 0xffff0000, v70
  v_lshlrev_b32 v102, 16, v71
  v_and_b32 v103, 0xffff0000, v71
  v_add_f32 v20, v72, v76
  v_add_f32 v21, v73, v77
  v_add_f32 v22, v74, v78
  v_add_f32 v23, v75, v79
  v_add_f32 v20, v20, v80
  v_add_f32 v21, v21, v81
  v_add_f32 v22, v22, v82
  v_add_f32 v23, v23, v83
  v_add_f32 v20, v20, v84
  v_add_f32 v21, v21, v85
  v_add_f32 v22, v22, v86
  v_add_f32 v23, v23, v87
  v_add_f32 v20, v20, v88
  v_add_f32 v21, v21, v89
  v_add_f32 v22, v22, v90
  v_add_f32 v23, v23, v91
  v_add_f32 v20, v20, v92
  v_add_f32 v21, v21, v93
  v_add_f32 v22, v22, v94
  v_add_f32 v23, v23, v95
  v_add_f32 v20, v20, v96
  v_add_f32 v21, v21, v97
  v_add_f32 v22, v22, v98
  v_add_f32 v23, v23, v99
  v_add_f32 v20, v20, v100
  v_add_f32 v21, v21, v101
  v_add_f32 v22, v22, v102
  v_add_f32 v23, v23, v103
  v_add_f32 v20, v20, v21
  v_add_f32 v22, v22, v23
  v_add_f32 v24, v20, v22
  s_nop 1
  v_add_f32_dpp v24, v24, v24 quad_perm:[1,0,3,2] row_mask:0xf bank_mask:0xf
  s_nop 1
  v_add_f32_dpp v24, v24, v24 quad_perm:[2,3,0,1] row_mask:0xf bank_mask:0xf
  s_nop 1
  v_add_f32_dpp v24, v24, v24 row_half_mirror row_mask:0xf bank_mask:0xf
  s_nop 1
  v_add_f32_dpp v24, v24, v24 row_mirror row_mask:0xf bank_mask:0xf
  v_mul_f32 v24, 0x3b000000, v24
  s_barrier
  v_sub_f32 v72, v72, v24
  v_sub_f32 v73, v73, v24
  v_sub_f32 v74, v74, v24
  v_sub_f32 v75, v75, v24
  v_sub_f32 v76, v76, v24
  v_sub_f32 v77, v77, v24
  v_sub_f32 v78, v78, v24
  v_sub_f32 v79, v79, v24
  v_sub_f32 v80, v80, v24
  v_sub_f32 v81, v81, v24
  v_sub_f32 v82, v82, v24
  v_sub_f32 v83, v83, v24
  v_sub_f32 v84, v84, v24
  v_sub_f32 v85, v85, v24
  v_sub_f32 v86, v86, v24
  v_sub_f32 v87, v87, v24
  v_sub_f32 v88, v88, v24
  v_sub_f32 v89, v89, v24
  v_sub_f32 v90, v90, v24
  v_sub_f32 v91, v91, v24
  v_sub_f32 v92, v92, v24
  v_sub_f32 v93, v93, v24
  v_sub_f32 v94, v94, v24
  v_sub_f32 v95, v95, v24
  v_sub_f32 v96, v96, v24
  v_sub_f32 v97, v97, v24
  v_sub_f32 v98, v98, v24
  v_sub_f32 v99, v99, v24
  v_sub_f32 v100, v100, v24
  v_sub_f32 v101, v101, v24
  v_sub_f32 v102, v102, v24
  v_sub_f32 v103, v103, v24
  v_mul_f32 v20, v72, v72
  v_mul_f32 v21, v73, v73
  v_mul_f32 v22, v74, v74
  v_mul_f32 v23, v75, v75
  v_fmac_f32 v20, v76, v76
  v_fmac_f32 v21, v77, v77
  v_fmac_f32 v22, v78, v78
  v_fmac_f32 v23, v79, v79
  v_fmac_f32 v20, v80, v80
  v_fmac_f32 v21, v81, v81
  v_fmac_f32 v22, v82, v82
  v_fmac_f32 v23, v83, v83
  v_fmac_f32 v20, v84, v84
  v_fmac_f32 v21, v85, v85
  v_fmac_f32 v22, v86, v86
  v_fmac_f32 v23, v87, v87
  v_fmac_f32 v20, v88, v88
  v_fmac_f32 v21, v89, v89
  v_fmac_f32 v22, v90, v90
  v_fmac_f32 v23, v91, v91
  v_fmac_f32 v20, v92, v92
  v_fmac_f32 v21, v93, v93
  v_fmac_f32 v22, v94, v94
  v_fmac_f32 v23, v95, v95
  v_fmac_f32 v20, v96, v96
  v_fmac_f32 v21, v97, v97
  v_fmac_f32 v22, v98, v98
  v_fmac_f32 v23, v99, v99
  v_fmac_f32 v20, v100, v100
  v_fmac_f32 v21, v101, v101
  v_fmac_f32 v22, v102, v102
  v_fmac_f32 v23, v103, v103
  v_add_f32 v20, v20, v21
  v_add_f32 v22, v22, v23
  v_add_f32 v25, v20, v22
  s_nop 1
  v_add_f32_dpp v25, v25, v25 quad_perm:[1,0,3,2] row_mask:0xf bank_mask:0xf
  s_nop 1
  v_add_f32_dpp v25, v25, v25 quad_perm:[2,3,0,1] row_mask:0xf bank_mask:0xf
  s_nop 1
  v_add_f32_dpp v25, v25, v25 row_half_mirror row_mask:0xf bank_mask:0xf
  s_nop 1
  v_add_f32_dpp v25, v25, v25 row_mirror row_mask:0xf bank_mask:0xf
  v_mov_b32 v20, 0x3727c5ac
  v_fmac_f32 v20, 0x3b000000, v25
  v_rsq_f32 v56, v20
  s_nop 0
  v_mul_f32 v58, -v24, v56
  v_lshlrev_b32 v19, 4, v16
  s_lshl_b32 s36, s46, 4
  s_add_u32 s36, s36, 21495808
  v_mov_b32 v57, s4
  v_mov_b32 v59, s4
  s_mov_b32 s38, 0x00010001
  s_mov_b32 s39, 0x00010001
  s_mov_b64 exec, s[38:39]
  buffer_store_dwordx4 v[56:59], v19, s[16:19], s36 offen sc1
  s_mov_b64 exec, -1
  s_barrier
  s_lshl_b32 s36, s33, 11
  s_add_u32 s36, s36, 21495808
  s_sub_u32 s37, s32, 6
  s_lshl_b32 s38, s37, 10
  s_add_u32 s36, s36, s38
  v_lshlrev_b32 v18, 4, v1
  s_lshl_b32 s37, s37, 6
  v_add_u32 v19, s37, v1
  v_lshlrev_b32 v22, 3, v19
  v_lshlrev_b32 v23, 2, v19
  v_add_u32 v22, 77824, v22
  v_add_u32 v23, 78848, v23
  s_mov_b32 s42, 0
  s_barrier
  s_barrier
  s_barrier
  buffer_load_dwordx4 v[60:63], v18, s[16:19], s36 offen sc1
  s_barrier
  s_barrier
  s_waitcnt vmcnt(0)
  v_cmp_ne_u32 vcc, s4, v61
  v_cmp_ne_u32 s[38:39], s4, v63
  s_nop 0
  s_or_b64 vcc, vcc, s[38:39]
  s_cbranch_vccz L_Q_a2
  buffer_load_dwordx4 v[60:63], v18, s[16:19], s36 offen sc1
L_Q_a2:
  s_barrier
L_Q_a1:
  s_waitcnt vmcnt(0)
  v_cmp_ne_u32 vcc, s4, v61
  v_cmp_ne_u32 s[38:39], s4, v63
  s_nop 0
  s_or_b64 vcc, vcc, s[38:39]
  s_cbranch_vccz L_Q_a1d
  s_add_u32 s42, s42, 1
  s_cmp_gt_u32 s42, 0x200000
  s_cbranch_scc1 L_Q_a1d
  s_sleep 2
  buffer_load_dwordx4 v[60:63], v18, s[16:19], s36 offen sc1
  s_branch L_Q_a1
L_Q_a1d:
  v_mov_b32 v61, v62
  ds_write_b64 v22, v[60:61]
  ds_write_b32 v23, v60
  ds_write_b32 v23, v62 offset:512
  s_setprio 3
  s_waitcnt lgkmcnt(0)
L_Q_hb1:
  s_barrier
L_Q_w0d:
  s_lshl_b32 s36, s34, 4
  s_add_u32 s36, s36, s33
  s_lshl_b32 s36, s36, 7
  s_add_u32 s36, s36, 24117248
  v_mov_b32 v16, s4
  s_barrier
  s_cmp_lg_u32 s32, 4
  s_cbranch_scc1 L_Q_done
  s_mov_b64 exec, 1
  buffer_store_dword v16, off, s[16:19], s36 sc1
  s_mov_b64 exec, -1
  s_branch L_Q_done
L_Q_comp:
  s_setprio 3
  s_lshr_b32 s45, s32, 1
  s_and_b32 s46, s32, 1
  v_and_b32 v16, 15, v1
  v_lshrrev_b32 v17, 4, v1
  v_bfe_u32 v18, v1, 1, 3
  v_xor_b32 v18, v18, v17
  v_lshlrev_b32 v18, 4, v18
  v_lshl_add_u32 v18, v16, 7, v18
  s_lshl_b32 s36, s45, 13
  s_lshl_b32 s37, s46, 12
  s_add_u32 s36, s36, s37
  v_add_u32 v2, s36, v18
  v_xor_b32 v3, 4096, v2
  v_xor_b32 v4, 64, v2
  v_xor_b32 v5, 64, v3
  v_and_b32 v19, 3, v1
  v_lshlrev_b32 v18, 3, v19
  v_bfe_u32 v20, v1, 3, 1
  v_lshl_add_u32 v18, v20, 6, v18
  v_bfe_u32 v20, v1, 2, 1
  v_lshl_add_u32 v18, v20, 8, v18
  v_xor_b32 v20, s46, v20
  v_lshl_add_u32 v18, v20, 5, v18
  v_bfe_u32 v20, v1, 4, 1
  v_lshl_add_u32 v18, v20, 7, v18
  v_lshlrev_b32 v21, 3, v19
  v_xor_b32 v20, s46, v20
  v_lshl_add_u32 v21, v20, 5, v21
  v_bfe_u32 v20, v1, 3, 1
  v_lshl_add_u32 v21, v20, 6, v21
  v_bfe_u32 v20, v1, 2, 2
  v_lshl_add_u32 v21, v20, 7, v21
  v_lshl_add_u32 v6, v17, 10, v21
  v_xor_b32 v7, 64, v6
  v_lshrrev_b32 v19, 5, v1
  v_lshl_add_u32 v8, v19, 10, v18
  v_and_b32 v18, 31, v1
  v_lshlrev_b32 v18, 3, v18
  v_lshl_add_u32 v9, v19, 9, v18
  v_add_u32 v6, 49152, v6
  v_add_u32 v7, 49152, v7
  v_add_u32 v8, 49152, v8
  v_add_u32 v9, 49152, v9
  s_mov_b32 s47, 0
  v_mov_b32 v12, 0x3f803f80
  v_mov_b32 v13, 0x3f803f80
  v_mov_b32 v14, 0x3f803f80
  v_mov_b32 v15, 0x3f803f80
  v_mov_b32 v48, 0
  v_mov_b32 v49, 0
  v_mov_b32 v50, 0
  v_mov_b32 v51, 0
  v_mov_b32 v52, 0
  v_mov_b32 v53, 0
  v_mov_b32 v54, 0
  v_mov_b32 v55, 0
  v_mov_b32 v56, 0
  v_mov_b32 v57, 0
  v_mov_b32 v58, 0
  v_mov_b32 v59, 0
  v_mov_b32 v60, 0
  v_mov_b32 v61, 0
  v_mov_b32 v62, 0
  v_mov_b32 v63, 0
  v_mov_b32 v64, 0
  v_mov_b32 v65, 0
  v_mov_b32 v66, 0
  v_mov_b32 v67, 0
  v_mov_b32 v68, 0
  v_mov_b32 v69, 0
  v_mov_b32 v70, 0
  v_mov_b32 v71, 0
  v_mov_b32 v72, 0
  v_mov_b32 v73, 0
  v_mov_b32 v74, 0
  v_mov_b32 v75, 0
  v_mov_b32 v76, 0
  v_mov_b32 v77, 0
  v_mov_b32 v78, 0
  v_mov_b32 v79, 0
  v_mov_b32 v80, 0
  v_mov_b32 v81, 0
  v_mov_b32 v82, 0
  v_mov_b32 v83, 0
  v_mov_b32 v84, 0
  v_mov_b32 v85, 0
  v_mov_b32 v86, 0
  v_mov_b32 v87, 0
  v_mov_b32 v88, 0
  v_mov_b32 v89, 0
  v_mov_b32 v90, 0
  v_mov_b32 v91, 0
  v_mov_b32 v92, 0
  v_mov_b32 v93, 0
  v_mov_b32 v94, 0
  v_mov_b32 v95, 0
  v_mov_b32 v96, 0
  v_mov_b32 v97, 0
  v_mov_b32 v98, 0
  v_mov_b32 v99, 0
  v_mov_b32 v100, 0
  v_mov_b32 v101, 0
  v_mov_b32 v102, 0
  v_mov_b32 v103, 0
  v_mov_b32 v104, 0
  v_mov_b32 v105, 0
  v_mov_b32 v106, 0
  v_mov_b32 v107, 0
  s_waitcnt lgkmcnt(0)
  s_mov_b32 s20, s10
  s_and_b32 s21, s11, 0xffff
  s_mov_b32 s22, 2097152
  s_mov_b32 s23, 0x20000
  s_mov_b32 s24, s12
  s_and_b32 s25, s13, 0xffff
  s_mov_b32 s26, 1572864
  s_mov_b32 s27, 0x20000
  s_mov_b32 s16, s8
  s_and_b32 s17, s9, 0xffff
  s_mov_b32 s18, 33554432
  s_mov_b32 s19, 0x20000
  s_add_u32 s14, s8, 21757952
  s_addc_u32 s15, s9, 0
  s_load_dword s4, s[14:15], 0
  s_waitcnt lgkmcnt(0)
  s_mul_i32 s4, s4, 0x9e3779b1
  s_add_u32 s4, s4, 0x7f4a7c15
  s_mov_b32 s42, 0
  s_barrier
  ds_read_b128 v[16:19], v2 offset:0
  ds_read_b128 v[20:23], v2 offset:2048
  ds_read_b64_tr_b16 v[32:33], v6 offset:0
  ds_read_b64_tr_b16 v[34:35], v6 offset:512
  ds_read_b64_tr_b16 v[36:37], v7 offset:0
  ds_read_b64_tr_b16 v[38:39], v7 offset:512
  ds_read_b64_tr_b16 v[40:41], v8 offset:4096
  ds_read_b64_tr_b16 v[42:43], v8 offset:4608
  ds_read_b128 v[24:27], v3 offset:0
  ds_read_b128 v[28:31], v3 offset:2048
  s_cmp_eq_u32 s45, 1
  s_cbranch_scc1 L_Q_c1
L_Q_c0:
  s_waitcnt lgkmcnt(6)
  v_mfma_f32_16x16x32_bf16 v[60:63], v[32:35], v[16:19], v[60:63]
  v_mfma_f32_16x16x32_bf16 v[64:67], v[32:35], v[20:23], v[64:67]
  v_mfma_f32_16x16x32_bf16 v[48:51], v[32:35], v[12:15], v[48:51]
  s_waitcnt lgkmcnt(4)
  v_mfma_f32_16x16x32_bf16 v[76:79], v[36:39], v[16:19], v[76:79]
  v_mfma_f32_16x16x32_bf16 v[80:83], v[36:39], v[20:23], v[80:83]
  v_mfma_f32_16x16x32_bf16 v[52:55], v[36:39], v[12:15], v[52:55]
  s_waitcnt lgkmcnt(2)
  v_mfma_f32_16x16x32_bf16 v[92:95], v[16:19], v[40:43], v[92:95]
  v_mfma_f32_16x16x32_bf16 v[96:99], v[20:23], v[40:43], v[96:99]
  v_mfma_f32_16x16x32_bf16 v[56:59], v[12:15], v[40:43], v[56:59]
  s_waitcnt lgkmcnt(0)
  ds_read_b128 v[16:19], v4 offset:0
  ds_read_b128 v[20:23], v4 offset:2048
  v_mfma_f32_16x16x32_bf16 v[68:71], v[32:35], v[24:27], v[68:71]
  v_mfma_f32_16x16x32_bf16 v[72:75], v[32:35], v[28:31], v[72:75]
  ds_read_b64_tr_b16 v[32:33], v6 offset:7168
  ds_read_b64_tr_b16 v[34:35], v6 offset:7680
  v_mfma_f32_16x16x32_bf16 v[84:87], v[36:39], v[24:27], v[84:87]
  v_mfma_f32_16x16x32_bf16 v[88:91], v[36:39], v[28:31], v[88:91]
  ds_read_b64_tr_b16 v[36:37], v7 offset:7168
  ds_read_b64_tr_b16 v[38:39], v7 offset:7680
  v_mfma_f32_16x16x32_bf16 v[100:103], v[24:27], v[40:43], v[100:103]
  v_mfma_f32_16x16x32_bf16 v[104:107], v[28:31], v[40:43], v[104:107]
  ds_read_b64_tr_b16 v[40:41], v8 offset:11264
  ds_read_b64_tr_b16 v[42:43], v8 offset:11776
  ds_read_b128 v[24:27], v5 offset:0
  ds_read_b128 v[28:31], v5 offset:2048
  s_waitcnt lgkmcnt(6)
  v_mfma_f32_16x16x32_bf16 v[60:63], v[32:35], v[16:19], v[60:63]
  v_mfma_f32_16x16x32_bf16 v[64:67], v[32:35], v[20:23], v[64:67]
  s_waitcnt lgkmcnt(4)
  v_mfma_f32_16x16x32_bf16 v[76:79], v[36:39], v[16:19], v[76:79]
  v_mfma_f32_16x16x32_bf16 v[80:83], v[36:39], v[20:23], v[80:83]
  s_waitcnt lgkmcnt(2)
  v_mfma_f32_16x16x32_bf16 v[92:95], v[16:19], v[40:43], v[92:95]
  v_mfma_f32_16x16x32_bf16 v[96:99], v[20:23], v[40:43], v[96:99]
  s_waitcnt lgkmcnt(0)
  s_add_u32 s47, s47, 1
  s_cmp_eq_u32 s47, 3
  s_cselect_b32 s47, 0, s47
  s_mov_b32 s48, 16384
  s_cmov_b32 s48, 4294934528
  v_add_u32 v2, s48, v2
  v_add_u32 v3, s48, v3
  v_add_u32 v4, s48, v4
  v_add_u32 v5, s48, v5
  s_barrier
  ds_read_b128 v[16:19], v2 offset:0
  ds_read_b128 v[20:23], v2 offset:2048
  v_mfma_f32_16x16x32_bf16 v[68:71], v[32:35], v[24:27], v[68:71]
  v_mfma_f32_16x16x32_bf16 v[72:75], v[32:35], v[28:31], v[72:75]
  ds_read_b64_tr_b16 v[32:33], v6 offset:14336
  ds_read_b64_tr_b16 v[34:35], v6 offset:14848
  v_mfma_f32_16x16x32_bf16 v[84:87], v[36:39], v[24:27], v[84:87]
  v_mfma_f32_16x16x32_bf16 v[88:91], v[36:39], v[28:31], v[88:91]
  ds_read_b64_tr_b16 v[36:37], v7 offset:14336
  ds_read_b64_tr_b16 v[38:39], v7 offset:14848
  v_mfma_f32_16x16x32_bf16 v[100:103], v[24:27], v[40:43], v[100:103]
  v_mfma_f32_16x16x32_bf16 v[104:107], v[28:31], v[40:43], v[104:107]
  ds_read_b64_tr_b16 v[40:41], v8 offset:18432
  ds_read_b64_tr_b16 v[42:43], v8 offset:18944
  ds_read_b128 v[24:27], v3 offset:0
  ds_read_b128 v[28:31], v3 offset:2048
  s_waitcnt lgkmcnt(6)
  v_mfma_f32_16x16x32_bf16 v[60:63], v[32:35], v[16:19], v[60:63]
  v_mfma_f32_16x16x32_bf16 v[64:67], v[32:35], v[20:23], v[64:67]
  v_mfma_f32_16x16x32_bf16 v[48:51], v[32:35], v[12:15], v[48:51]
  s_waitcnt lgkmcnt(4)
  v_mfma_f32_16x16x32_bf16 v[76:79], v[36:39], v[16:19], v[76:79]
  v_mfma_f32_16x16x32_bf16 v[80:83], v[36:39], v[20:23], v[80:83]
  v_mfma_f32_16x16x32_bf16 v[52:55], v[36:39], v[12:15], v[52:55]
  s_waitcnt lgkmcnt(2)
  v_mfma_f32_16x16x32_bf16 v[92:95], v[16:19], v[40:43], v[92:95]
  v_mfma_f32_16x16x32_bf16 v[96:99], v[20:23], v[40:43], v[96:99]
  v_mfma_f32_16x16x32_bf16 v[56:59], v[12:15], v[40:43], v[56:59]
  s_waitcnt lgkmcnt(0)
  ds_read_b128 v[16:19], v4 offset:0
  ds_read_b128 v[20:23], v4 offset:2048
  v_mfma_f32_16x16x32_bf16 v[68:71], v[32:35], v[24:27], v[68:71]
  v_mfma_f32_16x16x32_bf16 v[72:75], v[32:35], v[28:31], v[72:75]
  ds_read_b64_tr_b16 v[32:33], v6 offset:21504
  ds_read_b64_tr_b16 v[34:35], v6 offset:22016
  v_mfma_f32_16x16x32_bf16 v[84:87], v[36:39], v[24:27], v[84:87]
  v_mfma_f32_16x16x32_bf16 v[88:91], v[36:39], v[28:31], v[88:91]
  ds_read_b64_tr_b16 v[36:37], v7 offset:21504
  ds_read_b64_tr_b16 v[38:39], v7 offset:22016
  v_mfma_f32_16x16x32_bf16 v[100:103], v[24:27], v[40:43], v[100:103]
  v_mfma_f32_16x16x32_bf16 v[104:107], v[28:31], v[40:43], v[104:107]
  ds_read_b64_tr_b16 v[40:41], v8 offset:25600
  ds_read_b64_tr_b16 v[42:43], v8 offset:26112
  ds_read_b128 v[24:27], v5 offset:0
  ds_read_b128 v[28:31], v5 offset:2048
  s_add_u32 s42, s42, 1
  s_cmp_eq_u32 s42, 4
  s_cbranch_scc1 L_Q_cl0
  s_waitcnt lgkmcnt(6)
  v_mfma_f32_16x16x32_bf16 v[60:63], v[32:35], v[16:19], v[60:63]
  v_mfma_f32_16x16x32_bf16 v[64:67], v[32:35], v[20:23], v[64:67]
  s_waitcnt lgkmcnt(4)
  v_mfma_f32_16x16x32_bf16 v[76:79], v[36:39], v[16:19], v[76:79]
  v_mfma_f32_16x16x32_bf16 v[80:83], v[36:39], v[20:23], v[80:83]
  s_waitcnt lgkmcnt(2)
  v_mfma_f32_16x16x32_bf16 v[92:95], v[16:19], v[40:43], v[92:95]
  v_mfma_f32_16x16x32_bf16 v[96:99], v[20:23], v[40:43], v[96:99]
  s_waitcnt lgkmcnt(0)
  s_add_u32 s47, s47, 1
  s_cmp_eq_u32 s47, 3
  s_cselect_b32 s47, 0, s47
  s_mov_b32 s48, 16384
  s_cmov_b32 s48, 4294934528
  v_add_u32 v2, s48, v2
  v_add_u32 v3, s48, v3
  v_add_u32 v4, s48, v4
  v_add_u32 v5, s48, v5
  s_barrier
  ds_read_b128 v[16:19], v2 offset:0
  ds_read_b128 v[20:23], v2 offset:2048
  v_mfma_f32_16x16x32_bf16 v[68:71], v[32:35], v[24:27], v[68:71]
  v_mfma_f32_16x16x32_bf16 v[72:75], v[32:35], v[28:31], v[72:75]
  ds_read_b64_tr_b16 v[32:33], v6 offset:0
  ds_read_b64_tr_b16 v[34:35], v6 offset:512
  v_mfma_f32_16x16x32_bf16 v[84:87], v[36:39], v[24:27], v[84:87]
  v_mfma_f32_16x16x32_bf16 v[88:91], v[36:39], v[28:31], v[88:91]
  ds_read_b64_tr_b16 v[36:37], v7 offset:0
  ds_read_b64_tr_b16 v[38:39], v7 offset:512
  v_mfma_f32_16x16x32_bf16 v[100:103], v[24:27], v[40:43], v[100:103]
  v_mfma_f32_16x16x32_bf16 v[104:107], v[28:31], v[40:43], v[104:107]
  ds_read_b64_tr_b16 v[40:41], v8 offset:4096
  ds_read_b64_tr_b16 v[42:43], v8 offset:4608
  ds_read_b128 v[24:27], v3 offset:0
  ds_read_b128 v[28:31], v3 offset:2048
  s_branch L_Q_c0
L_Q_cl0:
  s_waitcnt lgkmcnt(6)
  v_mfma_f32_16x16x32_bf16 v[60:63], v[32:35], v[16:19], v[60:63]
  v_mfma_f32_16x16x32_bf16 v[64:67], v[32:35], v[20:23], v[64:67]
  s_waitcnt lgkmcnt(4)
  v_mfma_f32_16x16x32_bf16 v[76:79], v[36:39], v[16:19], v[76:79]
  v_mfma_f32_16x16x32_bf16 v[80:83], v[36:39], v[20:23], v[80:83]
  s_waitcnt lgkmcnt(2)
  v_mfma_f32_16x16x32_bf16 v[92:95], v[16:19], v[40:43], v[92:95]
  v_mfma_f32_16x16x32_bf16 v[96:99], v[20:23], v[40:43], v[96:99]
  s_waitcnt lgkmcnt(0)
  v_mfma_f32_16x16x32_bf16 v[68:71], v[32:35], v[24:27], v[68:71]
  v_mfma_f32_16x16x32_bf16 v[72:75], v[32:35], v[28:31], v[72:75]
  v_mfma_f32_16x16x32_bf16 v[84:87], v[36:39], v[24:27], v[84:87]
  v_mfma_f32_16x16x32_bf16 v[88:91], v[36:39], v[28:31], v[88:91]
  v_mfma_f32_16x16x32_bf16 v[100:103], v[24:27], v[40:43], v[100:103]
  v_mfma_f32_16x16x32_bf16 v[104:107], v[28:31], v[40:43], v[104:107]
  s_branch L_Q_epi
L_Q_c1:
  s_waitcnt lgkmcnt(6)
  v_mfma_f32_16x16x32_bf16 v[60:63], v[32:35], v[16:19], v[60:63]
  v_mfma_f32_16x16x32_bf16 v[64:67], v[32:35], v[20:23], v[64:67]
  s_waitcnt lgkmcnt(4)
  v_mfma_f32_16x16x32_bf16 v[76:79], v[36:39], v[16:19], v[76:79]
  v_mfma_f32_16x16x32_bf16 v[80:83], v[36:39], v[20:23], v[80:83]
  s_waitcnt lgkmcnt(2)
  v_mfma_f32_16x16x32_bf16 v[92:95], v[16:19], v[40:43], v[92:95]
  v_mfma_f32_16x16x32_bf16 v[96:99], v[20:23], v[40:43], v[96:99]
  s_waitcnt lgkmcnt(0)
  ds_read_b128 v[16:19], v4 offset:0
  ds_read_b128 v[20:23], v4 offset:2048
  v_mfma_f32_16x16x32_bf16 v[68:71], v[32:35], v[24:27], v[68:71]
  v_mfma_f32_16x16x32_bf16 v[72:75], v[32:35], v[28:31], v[72:75]
  ds_read_b64_tr_b16 v[32:33], v6 offset:7168
  ds_read_b64_tr_b16 v[34:35], v6 offset:7680
  v_mfma_f32_16x16x32_bf16 v[84:87], v[36:39], v[24:27], v[84:87]
  v_mfma_f32_16x16x32_bf16 v[88:91], v[36:39], v[28:31], v[88:91]
  ds_read_b64_tr_b16 v[36:37], v7 offset:7168
  ds_read_b64_tr_b16 v[38:39], v7 offset:7680
  v_mfma_f32_16x16x32_bf16 v[100:103], v[24:27], v[40:43], v[100:103]
  v_mfma_f32_16x16x32_bf16 v[104:107], v[28:31], v[40:43], v[104:107]
  ds_read_b64_tr_b16 v[40:41], v8 offset:11264
  ds_read_b64_tr_b16 v[42:43], v8 offset:11776
  ds_read_b128 v[24:27], v5 offset:0
  ds_read_b128 v[28:31], v5 offset:2048
  s_waitcnt lgkmcnt(6)
  v_mfma_f32_16x16x32_bf16 v[60:63], v[32:35], v[16:19], v[60:63]
  v_mfma_f32_16x16x32_bf16 v[64:67], v[32:35], v[20:23], v[64:67]
  v_mfma_f32_16x16x32_bf16 v[48:51], v[32:35], v[12:15], v[48:51]
  s_waitcnt lgkmcnt(4)
  v_mfma_f32_16x16x32_bf16 v[76:79], v[36:39], v[16:19], v[76:79]
  v_mfma_f32_16x16x32_bf16 v[80:83], v[36:39], v[20:23], v[80:83]
  v_mfma_f32_16x16x32_bf16 v[52:55], v[36:39], v[12:15], v[52:55]
  s_waitcnt lgkmcnt(2)
  v_mfma_f32_16x16x32_bf16 v[92:95], v[16:19], v[40:43], v[92:95]
  v_mfma_f32_16x16x32_bf16 v[96:99], v[20:23], v[40:43], v[96:99]
  v_mfma_f32_16x16x32_bf16 v[56:59], v[12:15], v[40:43], v[56:59]
  s_waitcnt lgkmcnt(0)
  s_add_u32 s47, s47, 1
  s_cmp_eq_u32 s47, 3
  s_cselect_b32 s47, 0, s47
  s_mov_b32 s48, 16384
  s_cmov_b32 s48, 4294934528
  v_add_u32 v2, s48, v2
  v_add_u32 v3, s48, v3
  v_add_u32 v4, s48, v4
  v_add_u32 v5, s48, v5
  s_barrier
  ds_read_b128 v[16:19], v2 offset:0
  ds_read_b128 v[20:23], v2 offset:2048
  v_mfma_f32_16x16x32_bf16 v[68:71], v[32:35], v[24:27], v[68:71]
  v_mfma_f32_16x16x32_bf16 v[72:75], v[32:35], v[28:31], v[72:75]
  ds_read_b64_tr_b16 v[32:33], v6 offset:14336
  ds_read_b64_tr_b16 v[34:35], v6 offset:14848
  v_mfma_f32_16x16x32_bf16 v[84:87], v[36:39], v[24:27], v[84:87]
  v_mfma_f32_16x16x32_bf16 v[88:91], v[36:39], v[28:31], v[88:91]
  ds_read_b64_tr_b16 v[36:37], v7 offset:14336
  ds_read_b64_tr_b16 v[38:39], v7 offset:14848
  v_mfma_f32_16x16x32_bf16 v[100:103], v[24:27], v[40:43], v[100:103]
  v_mfma_f32_16x16x32_bf16 v[104:107], v[28:31], v[40:43], v[104:107]
  ds_read_b64_tr_b16 v[40:41], v8 offset:18432
  ds_read_b64_tr_b16 v[42:43], v8 offset:18944
  ds_read_b128 v[24:27], v3 offset:0
  ds_read_b128 v[28:31], v3 offset:2048
  s_waitcnt lgkmcnt(6)
  v_mfma_f32_16x16x32_bf16 v[60:63], v[32:35], v[16:19], v[60:63]
  v_mfma_f32_16x16x32_bf16 v[64:67], v[32:35], v[20:23], v[64:67]
  s_waitcnt lgkmcnt(4)
  v_mfma_f32_16x16x32_bf16 v[76:79], v[36:39], v[16:19], v[76:79]
  v_mfma_f32_16x16x32_bf16 v[80:83], v[36:39], v[20:23], v[80:83]
  s_waitcnt lgkmcnt(2)
  v_mfma_f32_16x16x32_bf16 v[92:95], v[16:19], v[40:43], v[92:95]
  v_mfma_f32_16x16x32_bf16 v[96:99], v[20:23], v[40:43], v[96:99]
  s_waitcnt lgkmcnt(0)
  ds_read_b128 v[16:19], v4 offset:0
  ds_read_b128 v[20:23], v4 offset:2048
  v_mfma_f32_16x16x32_bf16 v[68:71], v[32:35], v[24:27], v[68:71]
  v_mfma_f32_16x16x32_bf16 v[72:75], v[32:35], v[28:31], v[72:75]
  ds_read_b64_tr_b16 v[32:33], v6 offset:21504
  ds_read_b64_tr_b16 v[34:35], v6 offset:22016
  v_mfma_f32_16x16x32_bf16 v[84:87], v[36:39], v[24:27], v[84:87]
  v_mfma_f32_16x16x32_bf16 v[88:91], v[36:39], v[28:31], v[88:91]
  ds_read_b64_tr_b16 v[36:37], v7 offset:21504
  ds_read_b64_tr_b16 v[38:39], v7 offset:22016
  v_mfma_f32_16x16x32_bf16 v[100:103], v[24:27], v[40:43], v[100:103]
  v_mfma_f32_16x16x32_bf16 v[104:107], v[28:31], v[40:43], v[104:107]
  ds_read_b64_tr_b16 v[40:41], v8 offset:25600
  ds_read_b64_tr_b16 v[42:43], v8 offset:26112
  ds_read_b128 v[24:27], v5 offset:0
  ds_read_b128 v[28:31], v5 offset:2048
  s_add_u32 s42, s42, 1
  s_cmp_eq_u32 s42, 4
  s_cbranch_scc1 L_Q_cl1
  s_waitcnt lgkmcnt(6)
  v_mfma_f32_16x16x32_bf16 v[60:63], v[32:35], v[16:19], v[60:63]
  v_mfma_f32_16x16x32_bf16 v[64:67], v[32:35], v[20:23], v[64:67]
  v_mfma_f32_16x16x32_bf16 v[48:51], v[32:35], v[12:15], v[48:51]
  s_waitcnt lgkmcnt(4)
  v_mfma_f32_16x16x32_bf16 v[76:79], v[36:39], v[16:19], v[76:79]
  v_mfma_f32_16x16x32_bf16 v[80:83], v[36:39], v[20:23], v[80:83]
  v_mfma_f32_16x16x32_bf16 v[52:55], v[36:39], v[12:15], v[52:55]
  s_waitcnt lgkmcnt(2)
  v_mfma_f32_16x16x32_bf16 v[92:95], v[16:19], v[40:43], v[92:95]
  v_mfma_f32_16x16x32_bf16 v[96:99], v[20:23], v[40:43], v[96:99]
  v_mfma_f32_16x16x32_bf16 v[56:59], v[12:15], v[40:43], v[56:59]
  s_waitcnt lgkmcnt(0)
  s_add_u32 s47, s47, 1
  s_cmp_eq_u32 s47, 3
  s_cselect_b32 s47, 0, s47
  s_mov_b32 s48, 16384
  s_cmov_b32 s48, 4294934528
  v_add_u32 v2, s48, v2
  v_add_u32 v3, s48, v3
  v_add_u32 v4, s48, v4
  v_add_u32 v5, s48, v5
  s_barrier
  ds_read_b128 v[16:19], v2 offset:0
  ds_read_b128 v[20:23], v2 offset:2048
  v_mfma_f32_16x16x32_bf16 v[68:71], v[32:35], v[24:27], v[68:71]
  v_mfma_f32_16x16x32_bf16 v[72:75], v[32:35], v[28:31], v[72:75]
  ds_read_b64_tr_b16 v[32:33], v6 offset:0
  ds_read_b64_tr_b16 v[34:35], v6 offset:512
  v_mfma_f32_16x16x32_bf16 v[84:87], v[36:39], v[24:27], v[84:87]
  v_mfma_f32_16x16x32_bf16 v[88:91], v[36:39], v[28:31], v[88:91]
  ds_read_b64_tr_b16 v[36:37], v7 offset:0
  ds_read_b64_tr_b16 v[38:39], v7 offset:512
  v_mfma_f32_16x16x32_bf16 v[100:103], v[24:27], v[40:43], v[100:103]
  v_mfma_f32_16x16x32_bf16 v[104:107], v[28:31], v[40:43], v[104:107]
  ds_read_b64_tr_b16 v[40:41], v8 offset:4096
  ds_read_b64_tr_b16 v[42:43], v8 offset:4608
  ds_read_b128 v[24:27], v3 offset:0
  ds_read_b128 v[28:31], v3 offset:2048
  s_branch L_Q_c1
L_Q_cl1:
  s_waitcnt lgkmcnt(6)
  v_mfma_f32_16x16x32_bf16 v[60:63], v[32:35], v[16:19], v[60:63]
  v_mfma_f32_16x16x32_bf16 v[64:67], v[32:35], v[20:23], v[64:67]
  v_mfma_f32_16x16x32_bf16 v[48:51], v[32:35], v[12:15], v[48:51]
  s_waitcnt lgkmcnt(4)
  v_mfma_f32_16x16x32_bf16 v[76:79], v[36:39], v[16:19], v[76:79]
  v_mfma_f32_16x16x32_bf16 v[80:83], v[36:39], v[20:23], v[80:83]
  v_mfma_f32_16x16x32_bf16 v[52:55], v[36:39], v[12:15], v[52:55]
  s_waitcnt lgkmcnt(2)
  v_mfma_f32_16x16x32_bf16 v[92:95], v[16:19], v[40:43], v[92:95]
  v_mfma_f32_16x16x32_bf16 v[96:99], v[20:23], v[40:43], v[96:99]
  v_mfma_f32_16x16x32_bf16 v[56:59], v[12:15], v[40:43], v[56:59]
  s_waitcnt lgkmcnt(0)
  v_mfma_f32_16x16x32_bf16 v[68:71], v[32:35], v[24:27], v[68:71]
  v_mfma_f32_16x16x32_bf16 v[72:75], v[32:35], v[28:31], v[72:75]
  v_mfma_f32_16x16x32_bf16 v[84:87], v[36:39], v[24:27], v[84:87]
  v_mfma_f32_16x16x32_bf16 v[88:91], v[36:39], v[28:31], v[88:91]
  v_mfma_f32_16x16x32_bf16 v[100:103], v[24:27], v[40:43], v[100:103]
  v_mfma_f32_16x16x32_bf16 v[104:107], v[28:31], v[40:43], v[104:107]
L_Q_epi:
  s_setprio 3
  s_lshl_b32 s49, s45, 2
  s_lshl_b32 s36, s46, 1
  s_add_u32 s49, s49, s36
  s_xor_b32 s50, s49, 2
  s_lshl_b32 s36, s46, 13
  s_lshl_b32 s37, s45, 12
  s_add_u32 s36, s36, s37
  v_lshlrev_b32 v4, 4, v1
  v_add_u32 v8, s36, v4
  v_xor_b32 v9, 4096, v8
  v_and_b32 v24, 15, v1
  v_lshrrev_b32 v25, 4, v1
  v_lshlrev_b32 v26, 3, v24
  s_lshl_b32 s36, s49, 7
  s_lshl_b32 s37, s50, 7
  v_add_u32 v2, s36, v26
  v_add_u32 v3, s37, v26
  v_add_u32 v30, 77824, v2
  v_add_u32 v31, 77824, v3
  s_lshl_b32 s36, s33, 3
  s_add_u32 s37, s36, s49
  s_add_u32 s38, s36, s50
  ds_write_b128 v8, v[48:51] offset:0
  ds_write_b128 v8, v[52:55] offset:1024
  ds_write_b128 v8, v[56:59] offset:2048
  v_lshlrev_b32 v27, 4, v25
  s_lshl_b32 s39, s49, 6
  s_lshl_b32 s40, s50, 6
  v_add_u32 v5, s39, v27
  v_add_u32 v6, s40, v27
  v_add_u32 v5, 77824, v5
  v_add_u32 v6, 77824, v6
  s_cmp_lt_u32 s34, 8
  s_mov_b32 s56, 1.0
  s_cmov_b32 s56, 0x3eb8aa3b
  s_lshl_b32 s37, s37, 9
  s_lshl_b32 s38, s38, 9
  s_lshl_b32 s41, s34, 2
  s_add_u32 s41, s41, s46
  s_lshl_b32 s41, s41, 16
  s_add_u32 s52, s41, s37
  s_add_u32 s53, s41, s38
  s_lshl_b32 s41, s34, 1
  s_add_u32 s41, s41, s46
  s_lshl_b32 s41, s41, 16
  s_add_u32 s41, s41, 4194304
  s_add_u32 s54, s41, s37
  s_add_u32 s55, s41, s38
  s_waitcnt lgkmcnt(0)
  s_barrier
  ds_read_b128 v[32:35], v9 offset:0
  ds_read_b128 v[36:39], v9 offset:1024
  ds_read_b128 v[40:43], v9 offset:2048
  ds_read_b64 v[16:17], v30 offset:0
  ds_read_b64 v[18:19], v30 offset:128
  ds_read_b64 v[20:21], v31 offset:0
  ds_read_b64 v[22:23], v31 offset:128
  ds_read_b128 v[108:111], v5 offset:1024
  ds_read_b128 v[112:115], v5 offset:1536
  ds_read_b128 v[116:119], v5 offset:1088
  ds_read_b128 v[120:123], v5 offset:1600
  s_waitcnt lgkmcnt(4)
  v_add_f32 v48, v48, v32
  v_add_f32 v49, v49, v33
  v_add_f32 v50, v50, v34
  v_add_f32 v51, v51, v35
  v_add_f32 v52, v52, v36
  v_add_f32 v53, v53, v37
  v_add_f32 v54, v54, v38
  v_add_f32 v55, v55, v39
  v_add_f32 v56, v56, v40
  v_add_f32 v57, v57, v41
  v_add_f32 v58, v58, v42
  v_add_f32 v59, v59, v43
  v_mul_f32 v16, s56, v16
  v_mul_f32 v17, s56, v17
  v_mul_f32 v18, s56, v18
  v_mul_f32 v19, s56, v19
  v_mul_f32 v20, s56, v20
  v_mul_f32 v21, s56, v21
  v_mul_f32 v22, s56, v22
  v_mul_f32 v23, s56, v23
  s_waitcnt lgkmcnt(0)
  v_mul_f32 v24, v56, v112
  v_mul_f32 v25, v56, v113
  v_mul_f32 v26, v56, v114
  v_mul_f32 v27, v56, v115
  v_mul_f32 v28, v56, v120
  v_mul_f32 v29, v56, v121
  v_mul_f32 v30, v56, v122
  v_mul_f32 v31, v56, v123
  v_fma_f32 v92, v92, v108, v24
  v_fma_f32 v93, v93, v109, v25
  v_fma_f32 v94, v94, v110, v26
  v_fma_f32 v95, v95, v111, v27
  v_fma_f32 v96, v96, v116, v28
  v_fma_f32 v97, v97, v117, v29
  v_fma_f32 v98, v98, v118, v30
  v_fma_f32 v99, v99, v119, v31
  ds_read_b128 v[108:111], v6 offset:1024
  ds_read_b128 v[112:115], v6 offset:1536
  ds_read_b128 v[116:119], v6 offset:1088
  ds_read_b128 v[120:123], v6 offset:1600
  v_cvt_pk_bf16_f32 v92, v92, v93
  v_cvt_pk_bf16_f32 v93, v94, v95
  v_cvt_pk_bf16_f32 v94, v96, v97
  v_cvt_pk_bf16_f32 v95, v98, v99
  s_nop 0
  v_permlane32_swap_b32 v92, v94
  v_permlane32_swap_b32 v93, v95
  buffer_store_dwordx4 v[92:95], v4, s[16:19], s54 offen offset:0 sc1
  v_mul_f32 v24, v48, v17
  v_mul_f32 v25, v49, v17
  v_mul_f32 v26, v50, v17
  v_mul_f32 v27, v51, v17
  v_mul_f32 v28, v48, v19
  v_mul_f32 v29, v49, v19
  v_mul_f32 v30, v50, v19
  v_mul_f32 v31, v51, v19
  v_fma_f32 v60, v60, v16, v24
  v_fma_f32 v61, v61, v16, v25
  v_fma_f32 v62, v62, v16, v26
  v_fma_f32 v63, v63, v16, v27
  v_fma_f32 v64, v64, v18, v28
  v_fma_f32 v65, v65, v18, v29
  v_fma_f32 v66, v66, v18, v30
  v_fma_f32 v67, v67, v18, v31
  v_cvt_pk_bf16_f32 v60, v60, v61
  v_cvt_pk_bf16_f32 v61, v62, v63
  v_cvt_pk_bf16_f32 v62, v64, v65
  v_cvt_pk_bf16_f32 v63, v66, v67
  s_nop 0
  v_permlane16_swap_b32 v60, v62
  v_permlane16_swap_b32 v61, v63
  buffer_store_dwordx4 v[60:63], v4, s[16:19], s52 offen offset:0 sc1
  v_mul_f32 v24, v48, v21
  v_mul_f32 v25, v49, v21
  v_mul_f32 v26, v50, v21
  v_mul_f32 v27, v51, v21
  v_mul_f32 v28, v48, v23
  v_mul_f32 v29, v49, v23
  v_mul_f32 v30, v50, v23
  v_mul_f32 v31, v51, v23
  v_fma_f32 v68, v68, v20, v24
  v_fma_f32 v69, v69, v20, v25
  v_fma_f32 v70, v70, v20, v26
  v_fma_f32 v71, v71, v20, v27
  v_fma_f32 v72, v72, v22, v28
  v_fma_f32 v73, v73, v22, v29
  v_fma_f32 v74, v74, v22, v30
  v_fma_f32 v75, v75, v22, v31
  v_cvt_pk_bf16_f32 v68, v68, v69
  v_cvt_pk_bf16_f32 v69, v70, v71
  v_cvt_pk_bf16_f32 v70, v72, v73
  v_cvt_pk_bf16_f32 v71, v74, v75
  s_nop 0
  v_permlane16_swap_b32 v68, v70
  v_permlane16_swap_b32 v69, v71
  buffer_store_dwordx4 v[68:71], v4, s[16:19], s53 offen offset:0 sc1
  s_add_u32 s52, s52, 131072
  s_add_u32 s53, s53, 131072
  v_mul_f32 v24, v52, v17
  v_mul_f32 v25, v53, v17
  v_mul_f32 v26, v54, v17
  v_mul_f32 v27, v55, v17
  v_mul_f32 v28, v52, v19
  v_mul_f32 v29, v53, v19
  v_mul_f32 v30, v54, v19
  v_mul_f32 v31, v55, v19
  v_fma_f32 v76, v76, v16, v24
  v_fma_f32 v77, v77, v16, v25
  v_fma_f32 v78, v78, v16, v26
  v_fma_f32 v79, v79, v16, v27
  v_fma_f32 v80, v80, v18, v28
  v_fma_f32 v81, v81, v18, v29
  v_fma_f32 v82, v82, v18, v30
  v_fma_f32 v83, v83, v18, v31
  v_cvt_pk_bf16_f32 v76, v76, v77
  v_cvt_pk_bf16_f32 v77, v78, v79
  v_cvt_pk_bf16_f32 v78, v80, v81
  v_cvt_pk_bf16_f32 v79, v82, v83
  s_nop 0
  v_permlane16_swap_b32 v76, v78
  v_permlane16_swap_b32 v77, v79
  buffer_store_dwordx4 v[76:79], v4, s[16:19], s52 offen offset:0 sc1
  v_mul_f32 v24, v52, v21
  v_mul_f32 v25, v53, v21
  v_mul_f32 v26, v54, v21
  v_mul_f32 v27, v55, v21
  v_mul_f32 v28, v52, v23
  v_mul_f32 v29, v53, v23
  v_mul_f32 v30, v54, v23
  v_mul_f32 v31, v55, v23
  v_fma_f32 v84, v84, v20, v24
  v_fma_f32 v85, v85, v20, v25
  v_fma_f32 v86, v86, v20, v26
  v_fma_f32 v87, v87, v20, v27
  v_fma_f32 v88, v88, v22, v28
  v_fma_f32 v89, v89, v22, v29
  v_fma_f32 v90, v90, v22, v30
  v_fma_f32 v91, v91, v22, v31
  v_cvt_pk_bf16_f32 v84, v84, v85
  v_cvt_pk_bf16_f32 v85, v86, v87
  v_cvt_pk_bf16_f32 v86, v88, v89
  v_cvt_pk_bf16_f32 v87, v90, v91
  s_nop 0
  v_permlane16_swap_b32 v84, v86
  v_permlane16_swap_b32 v85, v87
  buffer_store_dwordx4 v[84:87], v4, s[16:19], s53 offen offset:0 sc1
  s_waitcnt lgkmcnt(0)
  v_mul_f32 v24, v56, v112
  v_mul_f32 v25, v56, v113
  v_mul_f32 v26, v56, v114
  v_mul_f32 v27, v56, v115
  v_mul_f32 v28, v56, v120
  v_mul_f32 v29, v56, v121
  v_mul_f32 v30, v56, v122
  v_mul_f32 v31, v56, v123
  v_fma_f32 v100, v100, v108, v24
  v_fma_f32 v101, v101, v109, v25
  v_fma_f32 v102, v102, v110, v26
  v_fma_f32 v103, v103, v111, v27
  v_fma_f32 v104, v104, v116, v28
  v_fma_f32 v105, v105, v117, v29
  v_fma_f32 v106, v106, v118, v30
  v_fma_f32 v107, v107, v119, v31
  v_cvt_pk_bf16_f32 v100, v100, v101
  v_cvt_pk_bf16_f32 v101, v102, v103
  v_cvt_pk_bf16_f32 v102, v104, v105
  v_cvt_pk_bf16_f32 v103, v106, v107
  s_nop 0
  v_permlane32_swap_b32 v100, v102
  v_permlane32_swap_b32 v101, v103
  buffer_store_dwordx4 v[100:103], v4, s[16:19], s55 offen offset:0 sc1
  s_waitcnt vmcnt(0)
  s_barrier
L_Q_done:
  s_load_dwordx2 s[8:9], s[0:1], 80
  v_lshrrev_b32 v8, 6, v0
  v_and_b32 v1, 63, v0
  v_readfirstlane_b32 s28, v8
  s_and_b32 s32, s3, 7
  s_lshr_b32 s33, s3, 3
  s_lshl_b32 s26, s32, 2
  s_lshr_b32 s34, s33, 3
  s_add_u32 s26, s26, s34
  s_and_b32 s33, s33, 7
  s_cmp_eq_u32 s33, 7
  s_cselect_b32 s52, 5, 99
  s_lshl_b32 s27, s33, 3
  s_add_u32 s27, s27, s28
  s_lshl_b32 s40, s28, 10
  v_lshlrev_b32 v6, 4, v1
  s_lshl_b32 s35, s26, 16
  v_add_u32 v12, s40, v6
  s_waitcnt lgkmcnt(0)
  s_add_u32 s12, s8, s35
  s_addc_u32 s13, s9, 0
  s_add_u32 s16, s12, 4194304
  s_addc_u32 s17, s13, 0
  s_add_u32 s12, s12, 2097152
  s_addc_u32 s13, s13, 0
  s_and_b32 s13, s13, 0xffff
  s_and_b32 s17, s17, 0xffff
  s_mov_b32 s14, 65536
  s_mov_b32 s15, 0x20000
  s_mov_b32 s18, 65536
  s_mov_b32 s19, 0x20000
  s_mov_b32 s20, s8
  s_and_b32 s21, s9, 0xffff
  s_mov_b32 s22, 33554432
  s_mov_b32 s23, 0x20000
  v_lshrrev_b32 v8, 2, v1
  v_lshlrev_b32 v8, 9, v8
  v_and_b32 v9, 1, v1
  v_lshl_add_u32 v8, v9, 4, v8
  v_bfe_u32 v10, v1, 1, 1
  v_lshl_add_u32 v8, v10, 6, v8
  v_add_u32 v8, 65536, v8
  v_mul_u32_u24 v40, 0x3f80, v9
  v_lshl_add_u32 v40, v40, 16, v40
  v_mov_b32 v41, v40
  v_mov_b32 v42, v40
  v_mov_b32 v43, v40
  ds_write_b128 v8, v[40:43]
  v_and_b32 v8, 15, v1
  v_lshlrev_b32 v14, 4, v8
  v_lshrrev_b32 v9, 5, v1
  v_lshl_add_u32 v14, v9, 8, v14
  v_add_u32 v7, 8192, v14
  v_subrev_u32 v9, 4, v8
  v_cmp_gt_u32 vcc, 8, v9
  v_mov_b32 v10, 65536
  v_mov_b32 v11, 65600
  v_cndmask_b32 v10, v10, v11, vcc
  v_and_b32 v9, 11, v8
  v_cmp_eq_u32 vcc, 0, v9
  v_add_u32 v11, 16, v10
  v_bfe_u32 v9, v1, 4, 1
  v_cndmask_b32 v10, v10, v11, vcc
  v_cmp_eq_u32 vcc, 1, v9
  v_subrev_u32 v13, 1, v9
  v_mov_b32 v2, v6
  v_cndmask_b32 v7, v7, v10, vcc
  v_add_u32 v3, 16384, v6
  v_and_b32 v8, 16384, v13
  v_mov_b32 v4, v7
  v_add_u32 v5, v8, v7
  s_mov_b32 s24, 0xffff
  s_mov_b32 s25, 0xffff
  v_mov_b32 v80, 0
  v_mov_b32 v81, 0
  v_mov_b32 v82, 0
  v_mov_b32 v83, 0
  v_mov_b32 v84, 0
  v_mov_b32 v85, 0
  v_mov_b32 v86, 0
  v_mov_b32 v87, 0
  v_mov_b32 v88, 0
  v_mov_b32 v89, 0
  v_mov_b32 v90, 0
  v_mov_b32 v91, 0
  v_mov_b32 v92, 0
  v_mov_b32 v93, 0
  v_mov_b32 v94, 0
  v_mov_b32 v95, 0
  v_mov_b32 v44, 0
  v_mov_b32 v36, 0
  v_mov_b32 v45, 0
  v_mov_b32 v37, 0
  v_mov_b32 v46, 0
  v_mov_b32 v38, 0
  v_mov_b32 v47, 0
  v_mov_b32 v39, 0
  s_setprio 3
  s_cmp_lg_u32 s28, 4
  s_cbranch_scc1 L_attn_wq
  s_lshr_b32 s32, s26, 2
  s_lshr_b32 s33, s26, 1
  s_add_u32 s34, s32, 8
  v_mov_b32 v8, s34
  v_mov_b32 v9, s33
  v_cmp_lt_u32 vcc, 15, v1
  v_mov_b32 v10, s32
  v_and_b32 v11, 15, v1
  v_cndmask_b32 v8, v8, v9, vcc
  v_cmp_lt_u32 vcc, 31, v1
  s_lshr_b32 s32, s27, 3
  s_lshl_b32 s32, s32, 1
  v_and_b32 v9, 1, v1
  v_add_u32 v9, s32, v9
  v_cndmask_b32 v8, v8, v10, vcc
  v_cndmask_b32 v11, v11, v9, vcc
  v_lshl_add_u32 v8, v8, 4, v11
  v_lshlrev_b32 v8, 7, v8
  s_mov_b32 s32, 24117248
  s_mov_b32 s36, 0
L_attn_pq:
  buffer_load_dword v9, v8, s[20:23], s32 offen sc1
  s_waitcnt vmcnt(0)
  v_cmp_ne_u32 vcc, s4, v9
  s_add_u32 s36, s36, 1
  s_cbranch_vccz L_attn_wq
  s_cmp_gt_u32 s36, 0x200000
  s_cbranch_scc1 L_attn_wq
  s_sleep 2
  s_branch L_attn_pq
L_attn_wq:
  s_barrier
  s_add_u32 m0, s40, 0
  s_mov_b32 s39, 0
  buffer_load_dwordx4 v12, s[12:15], s39 offen sc1 lds
  s_add_u32 m0, s40, 8192
  s_nop 0
  buffer_load_dwordx4 v12, s[16:19], s39 offen sc1 lds
  s_lshl_b32 s32, s27, 10
  s_add_u32 s32, s32, s35
  buffer_load_dwordx4 v[16:19], v6, s[20:23], s32 offen sc1
  s_add_u32 m0, s40, 16384
  s_mov_b32 s39, 8192
  buffer_load_dwordx4 v12, s[12:15], s39 offen sc1 lds
  s_add_u32 m0, s40, 24576
  s_nop 0
  buffer_load_dwordx4 v12, s[16:19], s39 offen sc1 lds
  s_add_u32 m0, s40, 32768
  s_mov_b32 s39, 16384
  buffer_load_dwordx4 v12, s[12:15], s39 offen sc1 lds
  s_add_u32 m0, s40, 40960
  s_nop 0
  buffer_load_dwordx4 v12, s[16:19], s39 offen sc1 lds
  s_mov_b32 s36, 0
  s_mov_b32 s37, 16384
  s_mov_b32 s38, 49152
  s_mov_b32 s39, 24576
  s_waitcnt vmcnt(4) lgkmcnt(0)
  s_barrier
  ds_read_b128 v[20:23], v2
  ds_read_b128 v[24:27], v4
  ds_read_b128 v[32:35], v4 offset:512
  s_waitcnt lgkmcnt(2)
  v_mfma_f32_32x32x16_bf16 v[64:79], v[20:23], v[16:19], 0
  s_nop 11
  v_max3_f32 v8, v64, v65, v66
  v_max3_f32 v8, v8, v67, v68
  v_max3_f32 v8, v8, v69, v70
  v_max3_f32 v8, v8, v71, v72
  v_max3_f32 v8, v8, v73, v74
  v_max3_f32 v8, v8, v75, v76
  v_max3_f32 v8, v8, v77, v78
  v_max_f32 v8, v8, v79
  v_mov_b32 v9, v8
  s_nop 1
  v_permlane32_swap_b32 v8, v9
  v_max_f32 v8, v8, v9
  v_sub_f32 v96, 0, v8
  v_sub_f32 v97, 0, v8
  v_sub_f32 v98, 0, v8
  v_sub_f32 v99, 0, v8
  v_sub_f32 v100, 0, v8
  v_sub_f32 v101, 0, v8
  v_sub_f32 v102, 0, v8
  v_sub_f32 v103, 0, v8
  v_sub_f32 v104, 0, v8
  v_sub_f32 v105, 0, v8
  v_sub_f32 v106, 0, v8
  v_sub_f32 v107, 0, v8
  v_sub_f32 v108, 0, v8
  v_sub_f32 v109, 0, v8
  v_sub_f32 v110, 0, v8
  v_sub_f32 v111, 0, v8
  s_nop 1
  v_mfma_f32_32x32x16_bf16 v[48:63], v[20:23], v[16:19], v[96:111]
  ds_read_b128 v[20:23], v2 offset:1024
  v_mov_b32 v72, 0
  v_mov_b32 v73, 0
  v_mov_b32 v74, 0
  v_mov_b32 v75, 0
  v_mov_b32 v76, 0
  v_mov_b32 v77, 0
  v_mov_b32 v78, 0
  v_mov_b32 v79, 0
  s_nop 3
L_attn_loop:
  s_waitcnt lgkmcnt(0)
  v_mfma_f32_32x32x16_bf16 v[64:79], v[20:23], v[16:19], v[96:111]
  v_exp_f32 v48, v48
  v_exp_f32 v49, v49
  v_exp_f32 v50, v50
  v_cvt_pk_bf16_f32 v40, v48, v49
  v_exp_f32 v51, v51
  v_exp_f32 v52, v52
  v_cvt_pk_bf16_f32 v41, v50, v51
  v_exp_f32 v53, v53
  v_mfma_f32_32x32x16_bf16 v[80:95], v[36:39], v[44:47], v[80:95]
  ds_read_b128 v[20:23], v2 offset:2048
  v_exp_f32 v54, v54
  ds_read_b128 v[28:31], v4 offset:1024
  v_cvt_pk_bf16_f32 v42, v52, v53
  v_exp_f32 v55, v55
  ds_read_b128 v[36:39], v4 offset:1536
  v_exp_f32 v56, v56
  v_cvt_pk_bf16_f32 v43, v54, v55
  v_exp_f32 v57, v57
  v_exp_f32 v58, v58
  v_cvt_pk_bf16_f32 v44, v56, v57
  v_mfma_f32_32x32x16_bf16 v[80:95], v[24:27], v[40:43], v[80:95]
  v_exp_f32 v59, v59
  v_exp_f32 v60, v60
  v_cvt_pk_bf16_f32 v45, v58, v59
  v_exp_f32 v61, v61
  v_exp_f32 v62, v62
  v_exp_f32 v63, v63
  v_cvt_pk_bf16_f32 v46, v60, v61
  v_cvt_pk_bf16_f32 v47, v62, v63
  s_waitcnt lgkmcnt(0)
  v_mfma_f32_32x32x16_bf16 v[48:63], v[20:23], v[16:19], v[96:111]
  v_exp_f32 v64, v64
  v_exp_f32 v65, v65
  v_exp_f32 v66, v66
  v_cvt_pk_bf16_f32 v40, v64, v65
  v_exp_f32 v67, v67
  v_exp_f32 v68, v68
  v_cvt_pk_bf16_f32 v41, v66, v67
  v_exp_f32 v69, v69
  v_mfma_f32_32x32x16_bf16 v[80:95], v[32:35], v[44:47], v[80:95]
  ds_read_b128 v[20:23], v2 offset:3072
  v_exp_f32 v70, v70
  ds_read_b128 v[24:27], v4 offset:2048
  v_cvt_pk_bf16_f32 v42, v68, v69
  v_exp_f32 v71, v71
  ds_read_b128 v[32:35], v4 offset:2560
  v_exp_f32 v72, v72
  v_cvt_pk_bf16_f32 v43, v70, v71
  v_exp_f32 v73, v73
  v_exp_f32 v74, v74
  v_cvt_pk_bf16_f32 v44, v72, v73
  v_mfma_f32_32x32x16_bf16 v[80:95], v[28:31], v[40:43], v[80:95]
  v_exp_f32 v75, v75
  v_exp_f32 v76, v76
  v_cvt_pk_bf16_f32 v45, v74, v75
  v_exp_f32 v77, v77
  v_exp_f32 v78, v78
  v_exp_f32 v79, v79
  v_cvt_pk_bf16_f32 v46, v76, v77
  v_cvt_pk_bf16_f32 v47, v78, v79
  s_setprio 1
  s_waitcnt lgkmcnt(0)
  v_mfma_f32_32x32x16_bf16 v[64:79], v[20:23], v[16:19], v[96:111]
  v_exp_f32 v48, v48
  v_exp_f32 v49, v49
  v_exp_f32 v50, v50
  v_cvt_pk_bf16_f32 v40, v48, v49
  v_exp_f32 v51, v51
  v_exp_f32 v52, v52
  v_cvt_pk_bf16_f32 v41, v50, v51
  v_exp_f32 v53, v53
  v_mfma_f32_32x32x16_bf16 v[80:95], v[36:39], v[44:47], v[80:95]
  ds_read_b128 v[20:23], v2 offset:4096
  v_exp_f32 v54, v54
  ds_read_b128 v[28:31], v4 offset:3072
  v_cvt_pk_bf16_f32 v42, v52, v53
  v_exp_f32 v55, v55
  ds_read_b128 v[36:39], v4 offset:3584
  v_exp_f32 v56, v56
  v_cvt_pk_bf16_f32 v43, v54, v55
  v_exp_f32 v57, v57
  v_exp_f32 v58, v58
  v_cvt_pk_bf16_f32 v44, v56, v57
  v_mfma_f32_32x32x16_bf16 v[80:95], v[24:27], v[40:43], v[80:95]
  v_exp_f32 v59, v59
  v_exp_f32 v60, v60
  v_cvt_pk_bf16_f32 v45, v58, v59
  v_exp_f32 v61, v61
  v_exp_f32 v62, v62
  v_exp_f32 v63, v63
  v_cvt_pk_bf16_f32 v46, v60, v61
  v_cvt_pk_bf16_f32 v47, v62, v63
  s_waitcnt lgkmcnt(0)
  v_mfma_f32_32x32x16_bf16 v[48:63], v[20:23], v[16:19], v[96:111]
  v_exp_f32 v64, v64
  v_exp_f32 v65, v65
  v_exp_f32 v66, v66
  v_cvt_pk_bf16_f32 v40, v64, v65
  v_exp_f32 v67, v67
  v_exp_f32 v68, v68
  v_cvt_pk_bf16_f32 v41, v66, v67
  v_exp_f32 v69, v69
  v_mfma_f32_32x32x16_bf16 v[80:95], v[32:35], v[44:47], v[80:95]
  ds_read_b128 v[20:23], v2 offset:5120
  v_exp_f32 v70, v70
  ds_read_b128 v[24:27], v4 offset:4096
  v_cvt_pk_bf16_f32 v42, v68, v69
  v_exp_f32 v71, v71
  ds_read_b128 v[32:35], v4 offset:4608
  v_exp_f32 v72, v72
  v_cvt_pk_bf16_f32 v43, v70, v71
  v_exp_f32 v73, v73
  v_exp_f32 v74, v74
  v_cvt_pk_bf16_f32 v44, v72, v73
  v_mfma_f32_32x32x16_bf16 v[80:95], v[28:31], v[40:43], v[80:95]
  v_exp_f32 v75, v75
  v_exp_f32 v76, v76
  v_cvt_pk_bf16_f32 v45, v74, v75
  v_exp_f32 v77, v77
  v_exp_f32 v78, v78
  v_exp_f32 v79, v79
  v_cvt_pk_bf16_f32 v46, v76, v77
  v_cvt_pk_bf16_f32 v47, v78, v79
  s_waitcnt lgkmcnt(0)
  v_mfma_f32_32x32x16_bf16 v[64:79], v[20:23], v[16:19], v[96:111]
  v_exp_f32 v48, v48
  v_exp_f32 v49, v49
  v_exp_f32 v50, v50
  v_cvt_pk_bf16_f32 v40, v48, v49
  v_exp_f32 v51, v51
  v_exp_f32 v52, v52
  v_cvt_pk_bf16_f32 v41, v50, v51
  v_exp_f32 v53, v53
  v_mfma_f32_32x32x16_bf16 v[80:95], v[36:39], v[44:47], v[80:95]
  ds_read_b128 v[20:23], v2 offset:6144
  v_exp_f32 v54, v54
  ds_read_b128 v[28:31], v4 offset:5120
  v_cvt_pk_bf16_f32 v42, v52, v53
  v_exp_f32 v55, v55
  ds_read_b128 v[36:39], v4 offset:5632
  v_exp_f32 v56, v56
  v_cvt_pk_bf16_f32 v43, v54, v55
  v_exp_f32 v57, v57
  v_exp_f32 v58, v58
  v_cvt_pk_bf16_f32 v44, v56, v57
  v_mfma_f32_32x32x16_bf16 v[80:95], v[24:27], v[40:43], v[80:95]
  v_exp_f32 v59, v59
  v_exp_f32 v60, v60
  v_cvt_pk_bf16_f32 v45, v58, v59
  v_exp_f32 v61, v61
  v_exp_f32 v62, v62
  v_exp_f32 v63, v63
  v_cvt_pk_bf16_f32 v46, v60, v61
  v_cvt_pk_bf16_f32 v47, v62, v63
  s_setprio 0
  s_waitcnt lgkmcnt(0)
  v_mfma_f32_32x32x16_bf16 v[48:63], v[20:23], v[16:19], v[96:111]
  v_exp_f32 v64, v64
  v_exp_f32 v65, v65
  v_exp_f32 v66, v66
  v_cvt_pk_bf16_f32 v40, v64, v65
  v_exp_f32 v67, v67
  v_exp_f32 v68, v68
  v_cvt_pk_bf16_f32 v41, v66, v67
  v_exp_f32 v69, v69
  v_mfma_f32_32x32x16_bf16 v[80:95], v[32:35], v[44:47], v[80:95]
  ds_read_b128 v[20:23], v2 offset:7168
  v_exp_f32 v70, v70
  ds_read_b128 v[24:27], v4 offset:6144
  v_cvt_pk_bf16_f32 v42, v68, v69
  v_exp_f32 v71, v71
  ds_read_b128 v[32:35], v4 offset:6656
  v_exp_f32 v72, v72
  v_cvt_pk_bf16_f32 v43, v70, v71
  v_exp_f32 v73, v73
  v_exp_f32 v74, v74
  v_cvt_pk_bf16_f32 v44, v72, v73
  v_mfma_f32_32x32x16_bf16 v[80:95], v[28:31], v[40:43], v[80:95]
  v_exp_f32 v75, v75
  v_exp_f32 v76, v76
  v_cvt_pk_bf16_f32 v45, v74, v75
  v_exp_f32 v77, v77
  v_exp_f32 v78, v78
  v_exp_f32 v79, v79
  v_cvt_pk_bf16_f32 v46, v76, v77
  v_cvt_pk_bf16_f32 v47, v78, v79
  s_waitcnt lgkmcnt(0)
  v_mfma_f32_32x32x16_bf16 v[64:79], v[20:23], v[16:19], v[96:111]
  v_exp_f32 v48, v48
  v_exp_f32 v49, v49
  v_exp_f32 v50, v50
  v_cvt_pk_bf16_f32 v40, v48, v49
  v_exp_f32 v51, v51
  v_exp_f32 v52, v52
  v_cvt_pk_bf16_f32 v41, v50, v51
  v_exp_f32 v53, v53
  v_mfma_f32_32x32x16_bf16 v[80:95], v[36:39], v[44:47], v[80:95]
  s_waitcnt vmcnt(2)
  s_barrier
  s_add_u32 m0, s38, s40
  s_add_u32 s32, s38, 8192
  buffer_load_dwordx4 v12, s[12:15], s39 offen sc1 lds
  s_add_u32 m0, s32, s40
  s_add_u32 s38, s38, 16384
  buffer_load_dwordx4 v12, s[16:19], s39 offen sc1 lds
  s_and_b32 s38, s38, 65535
  s_add_u32 s39, s39, 8192
  ds_read_b128 v[20:23], v3 offset:0
  v_exp_f32 v54, v54
  ds_read_b128 v[28:31], v4 offset:7168
  v_cvt_pk_bf16_f32 v42, v52, v53
  v_exp_f32 v55, v55
  ds_read_b128 v[36:39], v4 offset:7680
  v_exp_f32 v56, v56
  v_cvt_pk_bf16_f32 v43, v54, v55
  v_exp_f32 v57, v57
  v_exp_f32 v58, v58
  v_cvt_pk_bf16_f32 v44, v56, v57
  v_mfma_f32_32x32x16_bf16 v[80:95], v[24:27], v[40:43], v[80:95]
  v_exp_f32 v59, v59
  v_exp_f32 v60, v60
  v_cvt_pk_bf16_f32 v45, v58, v59
  v_exp_f32 v61, v61
  v_exp_f32 v62, v62
  v_exp_f32 v63, v63
  v_cvt_pk_bf16_f32 v46, v60, v61
  v_cvt_pk_bf16_f32 v47, v62, v63
  s_setprio 3
  s_waitcnt lgkmcnt(0)
  v_mfma_f32_32x32x16_bf16 v[48:63], v[20:23], v[16:19], v[96:111]
  v_exp_f32 v64, v64
  v_exp_f32 v65, v65
  v_exp_f32 v66, v66
  v_cvt_pk_bf16_f32 v40, v64, v65
  v_exp_f32 v67, v67
  v_exp_f32 v68, v68
  v_cvt_pk_bf16_f32 v41, v66, v67
  v_exp_f32 v69, v69
  v_mfma_f32_32x32x16_bf16 v[80:95], v[32:35], v[44:47], v[80:95]
  ds_read_b128 v[20:23], v3 offset:1024
  v_exp_f32 v70, v70
  ds_read_b128 v[24:27], v5 offset:0
  v_cvt_pk_bf16_f32 v42, v68, v69
  v_exp_f32 v71, v71
  ds_read_b128 v[32:35], v5 offset:512
  v_exp_f32 v72, v72
  v_cvt_pk_bf16_f32 v43, v70, v71
  v_exp_f32 v73, v73
  v_exp_f32 v74, v74
  v_cvt_pk_bf16_f32 v44, v72, v73
  v_mfma_f32_32x32x16_bf16 v[80:95], v[28:31], v[40:43], v[80:95]
  v_exp_f32 v75, v75
  v_exp_f32 v76, v76
  v_cvt_pk_bf16_f32 v45, v74, v75
  v_exp_f32 v77, v77
  v_exp_f32 v78, v78
  v_exp_f32 v79, v79
  v_cvt_pk_bf16_f32 v46, v76, v77
  v_cvt_pk_bf16_f32 v47, v78, v79
  v_mov_b32 v2, v3
  v_mov_b32 v4, v5
  s_add_u32 s37, s37, 16384
  s_and_b32 s37, s37, 65535
  s_add_u32 s36, s36, 1
  v_add_u32 v3, s37, v6
  v_and_b32 v5, s37, v13
  v_add_u32 v5, v5, v7
  s_cmp_lt_u32 s36, 8
  s_cbranch_scc1 L_attn_loop
  v_mfma_f32_32x32x16_bf16 v[80:95], v[36:39], v[44:47], v[80:95]
  s_waitcnt vmcnt(0) lgkmcnt(0)
L_attn_fin:
  s_nop 10
  v_add_f32 v8, v88, abs(v80)
  v_add_f32 v8, v8, abs(v81)
  v_add_f32 v8, v8, abs(v82)
  v_add_f32 v8, v8, abs(v83)
  v_add_f32 v8, v8, abs(v84)
  v_add_f32 v8, v8, abs(v85)
  v_add_f32 v8, v8, abs(v86)
  v_add_f32 v8, v8, abs(v87)
  v_mov_b32 v9, 0x5f800000
  v_cmp_nlt_f32 vcc, v8, v9
  s_cmp_eq_u32 s36, 8
  s_cselect_b64 s[32:33], vcc, 0
  s_cmp_lg_u64 s[32:33], 0
  s_cbranch_scc1 L_attn_slow
  v_rcp_f32 v8, v88
  v_bfe_u32 v10, v1, 4, 1
  v_lshl_add_u32 v9, v10, 14, v14
  s_lshl_b32 s32, s27, 15
  s_lshl_b32 s33, s26, 9
  s_add_u32 s32, s32, s33
  s_add_u32 s32, s32, 14680064
  v_mul_f32 v80, v80, v8
  v_mul_f32 v81, v81, v8
  v_mul_f32 v82, v82, v8
  v_mul_f32 v83, v83, v8
  v_mul_f32 v84, v84, v8
  v_mul_f32 v85, v85, v8
  v_mul_f32 v86, v86, v8
  v_mul_f32 v87, v87, v8
  v_cvt_pk_bf16_f32 v40, v80, v81
  v_cvt_pk_bf16_f32 v41, v82, v83
  v_cvt_pk_bf16_f32 v42, v84, v85
  v_cvt_pk_bf16_f32 v43, v86, v87
  s_nop 0
  v_permlane32_swap_b32 v40, v42
  v_permlane32_swap_b32 v41, v43
  buffer_store_dwordx4 v[40:43], v9, s[20:23], s32 offen sc1
  s_lshr_b32 s32, s27, 3
  s_lshl_b32 s32, s32, 12
  s_lshl_b32 s33, s26, 7
  s_add_u32 s32, s32, s33
  s_add_u32 s32, s32, 23101440
  v_mov_b32 v8, s4
  s_waitcnt vmcnt(0)
  s_barrier
  s_cmp_lg_u32 s28, 4
  s_cbranch_scc1 L_attn_nf
  s_mov_b64 exec, 1
  buffer_store_dword v8, off, s[20:23], s32 sc1
L_attn_nf:
  s_mov_b64 exec, -1
  s_endpgm
L_attn_slow:
  s_mov_b32 s36, 9
  s_mov_b32 s39, 0
  v_mov_b32 v8, 0xff800000
L_attn_slow1:
  buffer_load_dwordx4 v[20:23], v6, s[12:15], s39 offen sc1
  s_waitcnt vmcnt(0)
  v_mfma_f32_32x32x16_bf16 v[48:63], v[20:23], v[16:19], 0
  s_add_u32 s39, s39, 1024
  s_nop 10
  v_max3_f32 v8, v8, v48, v49
  v_max3_f32 v8, v8, v50, v51
  v_max3_f32 v8, v8, v52, v53
  v_max3_f32 v8, v8, v54, v55
  v_max3_f32 v8, v8, v56, v57
  v_max3_f32 v8, v8, v58, v59
  v_max3_f32 v8, v8, v60, v61
  v_max3_f32 v8, v8, v62, v63
  s_cmp_lt_u32 s39, 65536
  s_cbranch_scc1 L_attn_slow1
  v_mov_b32 v9, v8
  s_nop 1
  v_permlane32_swap_b32 v8, v9
  v_max_f32 v8, v8, v9
  s_mov_b32 s39, 0
  v_sub_f32 v96, 0, v8
  v_mov_b32 v80, 0
  v_sub_f32 v97, 0, v8
  v_mov_b32 v81, 0
  v_sub_f32 v98, 0, v8
  v_mov_b32 v82, 0
  v_sub_f32 v99, 0, v8
  v_mov_b32 v83, 0
  v_sub_f32 v100, 0, v8
  v_mov_b32 v84, 0
  v_sub_f32 v101, 0, v8
  v_mov_b32 v85, 0
  v_sub_f32 v102, 0, v8
  v_mov_b32 v86, 0
  v_sub_f32 v103, 0, v8
  v_mov_b32 v87, 0
  v_sub_f32 v104, 0, v8
  v_mov_b32 v88, 0
  v_sub_f32 v105, 0, v8
  v_mov_b32 v89, 0
  v_sub_f32 v106, 0, v8
  v_mov_b32 v90, 0
  v_sub_f32 v107, 0, v8
  v_mov_b32 v91, 0
  v_sub_f32 v108, 0, v8
  v_mov_b32 v92, 0
  v_sub_f32 v109, 0, v8
  v_mov_b32 v93, 0
  v_sub_f32 v110, 0, v8
  v_mov_b32 v94, 0
  v_sub_f32 v111, 0, v8
  v_mov_b32 v95, 0
L_attn_slow2:
  buffer_load_dwordx4 v[20:23], v6, s[12:15], s39 offen sc1
  s_mov_b64 exec, s[24:25]
  buffer_load_dwordx4 v[24:27], v14, s[16:19], s39 offen sc1
  buffer_load_dwordx4 v[32:35], v14, s[16:19], s39 offen offset:512 sc1
  s_mov_b64 exec, -1
  s_waitcnt vmcnt(0)
  v_mfma_f32_32x32x16_bf16 v[48:63], v[20:23], v[16:19], v[96:111]
  s_add_u32 s39, s39, 1024
  s_nop 10
  v_exp_f32 v48, v48
  v_exp_f32 v49, v49
  v_exp_f32 v50, v50
  v_exp_f32 v51, v51
  v_exp_f32 v52, v52
  v_exp_f32 v53, v53
  v_exp_f32 v54, v54
  v_exp_f32 v55, v55
  v_exp_f32 v56, v56
  v_exp_f32 v57, v57
  v_exp_f32 v58, v58
  v_exp_f32 v59, v59
  v_exp_f32 v60, v60
  v_exp_f32 v61, v61
  v_exp_f32 v62, v62
  v_exp_f32 v63, v63
  v_cvt_pk_bf16_f32 v40, v48, v49
  v_cvt_pk_bf16_f32 v41, v50, v51
  v_cvt_pk_bf16_f32 v42, v52, v53
  v_cvt_pk_bf16_f32 v43, v54, v55
  v_cvt_pk_bf16_f32 v44, v56, v57
  v_cvt_pk_bf16_f32 v45, v58, v59
  v_cvt_pk_bf16_f32 v46, v60, v61
  v_cvt_pk_bf16_f32 v47, v62, v63
  v_mfma_f32_32x32x16_bf16 v[80:95], v[24:27], v[40:43], v[80:95]
  s_nop 0
  v_mfma_f32_32x32x16_bf16 v[80:95], v[32:35], v[44:47], v[80:95]
  s_cmp_lt_u32 s39, 65536
  s_cbranch_scc1 L_attn_slow2
  s_branch L_attn_fin
L_role_g:
  s_load_dwordx2 s[8:9], s[0:1], 80
  s_load_dwordx2 s[10:11], s[0:1], 0
  s_load_dwordx2 s[12:13], s[0:1], 32
  v_lshrrev_b32 v16, 6, v0
  v_and_b32 v1, 63, v0
  v_readfirstlane_b32 s32, v16
  s_lshr_b32 s37, s3, 3
  s_and_b32 s36, s3, 1
  s_lshl_b32 s33, s36, 3
  s_and_b32 s38, s37, 7
  s_add_u32 s33, s33, s38
  s_lshl_b32 s34, s3, 1
  s_and_b32 s34, s34, 12
  s_lshr_b32 s38, s37, 3
  s_add_u32 s34, s34, s38
  s_and_b32 s36, s34, 7
  s_lshl_b32 s43, s36, 7
  s_mul_i32 s44, s36, 96
  s_cmp_lt_u32 s34, 8
  s_mov_b32 s36, 768
  s_cmov_b32 s36, 1792
  s_cselect_b32 s37, 0, 2816
  s_add_u32 s43, s43, s36
  s_add_u32 s44, s44, s37
  s_cmp_lt_u32 s32, 4
  s_cbranch_scc1 L_Z_comp
  s_cmp_ge_u32 s32, 6
  s_cbranch_scc1 L_Z_aux
  s_setprio 0
  s_sub_u32 s45, s32, 4
  v_lshrrev_b32 v16, 3, v1
  v_and_b32 v17, 7, v1
  v_lshrrev_b32 v18, 4, v1
  v_xor_b32 v18, v17, v18
  v_lshlrev_b32 v18, 4, v18
  v_lshl_add_u32 v48, v16, 10, v18
  v_xor_b32 v49, 64, v48
  v_bfe_u32 v19, v1, 4, 1
  v_lshlrev_b32 v18, 2, v19
  v_xor_b32 v18, v18, v17
  v_lshlrev_b32 v18, 4, v18
  v_mul_u32_u24 v50, 3584, v16
  v_add_u32 v50, v50, v18
  v_xor_b32 v51, 32, v50
  v_lshlrev_b32 v18, 1, v19
  v_and_b32 v20, 3, v1
  v_xor_b32 v18, v18, v20
  v_lshlrev_b32 v18, 4, v18
  v_bfe_u32 v21, v1, 5, 1
  v_bfe_u32 v22, v1, 3, 1
  v_lshlrev_b32 v16, 3, v22
  v_lshl_add_u32 v16, v21, 2, v16
  v_bfe_u32 v20, v1, 2, 1
  v_lshl_add_u32 v16, v20, 1, v16
  v_add_u32 v16, v16, v19
  v_mul_u32_u24 v52, 3584, v16
  v_add_u32 v52, v52, v18
  v_bfe_u32 v16, v1, 1, 2
  v_lshl_add_u32 v16, v19, 2, v16
  v_lshl_add_u32 v16, v22, 3, v16
  v_lshl_add_u32 v16, v21, 4, v16
  v_mul_u32_u24 v53, 3584, v16
  v_and_b32 v16, 1, v1
  v_lshl_add_u32 v53, v16, 4, v53
  s_lshl_b32 s46, s33, 17
  s_lshl_b32 s37, s45, 16
  s_add_u32 s46, s46, s37
  s_lshl_b32 s52, s45, 13
  s_mul_i32 s53, s45, 7168
  s_add_u32 s53, s53, 49152
  s_mul_i32 s47, s45, 114688
  s_lshl_b32 s48, s34, 1
  s_add_u32 s48, s48, s33
  s_add_u32 s48, s48, 1
  s_and_b32 s48, s48, 7
  s_waitcnt lgkmcnt(0)
  s_mov_b32 s20, s10
  s_and_b32 s21, s11, 0xffff
  s_mov_b32 s22, 2097152
  s_mov_b32 s23, 0x20000
  s_mov_b32 s24, s12
  s_and_b32 s25, s13, 0xffff
  s_mov_b32 s26, 1835008
  s_mov_b32 s27, 0x20000
  s_mov_b32 s16, s8
  s_and_b32 s17, s9, 0xffff
  s_mov_b32 s18, 33554432
  s_mov_b32 s19, 0x20000
  s_add_u32 s14, s8, 21757952
  s_addc_u32 s15, s9, 0
  s_load_dword s4, s[14:15], 0
  s_mov_b32 s54, s48
  s_mov_b32 s55, s52
  s_mul_i32 s50, s48, 229376
  s_add_u32 s50, s50, s47
  s_add_u32 s51, s50, s44
  s_add_u32 s50, s50, s43
  s_add_u32 s48, s48, 1
  s_and_b32 s48, s48, 7
  s_add_u32 m0, s53, 0
  s_add_u32 s39, s50, 0
  buffer_load_dwordx4 v50, s[24:27], s39 offen lds
  s_add_u32 m0, s53, 1024
  s_add_u32 s39, s50, 28672
  buffer_load_dwordx4 v51, s[24:27], s39 offen lds
  s_add_u32 m0, s53, 2048
  s_add_u32 s39, s50, 57344
  buffer_load_dwordx4 v50, s[24:27], s39 offen lds
  s_add_u32 m0, s53, 3072
  s_add_u32 s39, s50, 86016
  buffer_load_dwordx4 v51, s[24:27], s39 offen lds
  s_add_u32 m0, s53, 4096
  s_add_u32 s39, s51, 0
  buffer_load_dwordx4 v52, s[24:27], s39 offen lds
  s_add_u32 m0, s53, 5120
  s_add_u32 s39, s51, 57344
  buffer_load_dwordx4 v52, s[24:27], s39 offen lds
  s_add_u32 m0, s53, 6144
  s_add_u32 s39, s51, 64
  buffer_load_dwordx4 v53, s[24:27], s39 offen lds
  s_lshl_b32 s49, s54, 7
  s_add_u32 s49, s49, s46
  s_add_u32 s54, s54, 1
  s_and_b32 s54, s54, 7
  s_add_u32 m0, s55, 0
  s_add_u32 s39, s49, 0
  buffer_load_dwordx4 v48, s[20:23], s39 offen lds
  s_add_u32 m0, s55, 1024
  s_add_u32 s39, s49, 8192
  buffer_load_dwordx4 v49, s[20:23], s39 offen lds
  s_add_u32 m0, s55, 2048
  s_add_u32 s39, s49, 16384
  buffer_load_dwordx4 v48, s[20:23], s39 offen lds
  s_add_u32 m0, s55, 3072
  s_add_u32 s39, s49, 24576
  buffer_load_dwordx4 v49, s[20:23], s39 offen lds
  s_add_u32 m0, s55, 4096
  s_add_u32 s39, s49, 32768
  buffer_load_dwordx4 v48, s[20:23], s39 offen lds
  s_add_u32 m0, s55, 5120
  s_add_u32 s39, s49, 40960
  buffer_load_dwordx4 v49, s[20:23], s39 offen lds
  s_add_u32 m0, s55, 6144
  s_add_u32 s39, s49, 49152
  buffer_load_dwordx4 v48, s[20:23], s39 offen lds
  s_add_u32 m0, s55, 7168
  s_add_u32 s39, s49, 57344
  buffer_load_dwordx4 v49, s[20:23], s39 offen lds
  s_add_u32 s55, s55, 16384
  s_cmp_ge_u32 s55, 49152
  s_cselect_b32 s55, s52, s55
  s_mul_i32 s50, s48, 229376
  s_add_u32 s50, s50, s47
  s_add_u32 s51, s50, s44
  s_add_u32 s50, s50, s43
  s_add_u32 s48, s48, 1
  s_and_b32 s48, s48, 7
  s_add_u32 m0, s53, 14336
  s_add_u32 s39, s50, 0
  buffer_load_dwordx4 v50, s[24:27], s39 offen lds
  s_add_u32 m0, s53, 15360
  s_add_u32 s39, s50, 28672
  buffer_load_dwordx4 v51, s[24:27], s39 offen lds
  s_add_u32 m0, s53, 16384
  s_add_u32 s39, s50, 57344
  buffer_load_dwordx4 v50, s[24:27], s39 offen lds
  s_add_u32 m0, s53, 17408
  s_add_u32 s39, s50, 86016
  buffer_load_dwordx4 v51, s[24:27], s39 offen lds
  s_add_u32 m0, s53, 18432
  s_add_u32 s39, s51, 0
  buffer_load_dwordx4 v52, s[24:27], s39 offen lds
  s_add_u32 m0, s53, 19456
  s_add_u32 s39, s51, 57344
  buffer_load_dwordx4 v52, s[24:27], s39 offen lds
  s_add_u32 m0, s53, 20480
  s_add_u32 s39, s51, 64
  buffer_load_dwordx4 v53, s[24:27], s39 offen lds
  s_lshl_b32 s49, s54, 7
  s_add_u32 s49, s49, s46
  s_add_u32 s54, s54, 1
  s_and_b32 s54, s54, 7
  s_add_u32 m0, s55, 0
  s_add_u32 s39, s49, 0
  buffer_load_dwordx4 v48, s[20:23], s39 offen lds
  s_add_u32 m0, s55, 1024
  s_add_u32 s39, s49, 8192
  buffer_load_dwordx4 v49, s[20:23], s39 offen lds
  s_add_u32 m0, s55, 2048
  s_add_u32 s39, s49, 16384
  buffer_load_dwordx4 v48, s[20:23], s39 offen lds
  s_add_u32 m0, s55, 3072
  s_add_u32 s39, s49, 24576
  buffer_load_dwordx4 v49, s[20:23], s39 offen lds
  s_add_u32 m0, s55, 4096
  s_add_u32 s39, s49, 32768
  buffer_load_dwordx4 v48, s[20:23], s39 offen lds
  s_add_u32 m0, s55, 5120
  s_add_u32 s39, s49, 40960
  buffer_load_dwordx4 v49, s[20:23], s39 offen lds
  s_add_u32 m0, s55, 6144
  s_add_u32 s39, s49, 49152
  buffer_load_dwordx4 v48, s[20:23], s39 offen lds
  s_add_u32 m0, s55, 7168
  s_add_u32 s39, s49, 57344
  buffer_load_dwordx4 v49, s[20:23], s39 offen lds
  s_add_u32 s55, s55, 16384
  s_cmp_ge_u32 s55, 49152
  s_cselect_b32 s55, s52, s55
  s_waitcnt lgkmcnt(0)
  s_mul_i32 s4, s4, 0x9e3779b1
  s_add_u32 s4, s4, 0x7f4a7c15
  s_waitcnt vmcnt(15)
  s_barrier
  s_lshl_b32 s49, s54, 7
  s_add_u32 s49, s49, s46
  s_add_u32 s54, s54, 1
  s_and_b32 s54, s54, 7
  s_add_u32 m0, s55, 0
  s_add_u32 s39, s49, 0
  buffer_load_dwordx4 v48, s[20:23], s39 offen lds
  s_add_u32 m0, s55, 1024
  s_add_u32 s39, s49, 8192
  buffer_load_dwordx4 v49, s[20:23], s39 offen lds
  s_add_u32 m0, s55, 2048
  s_add_u32 s39, s49, 16384
  buffer_load_dwordx4 v48, s[20:23], s39 offen lds
  s_add_u32 m0, s55, 3072
  s_add_u32 s39, s49, 24576
  buffer_load_dwordx4 v49, s[20:23], s39 offen lds
  s_add_u32 m0, s55, 4096
  s_add_u32 s39, s49, 32768
  buffer_load_dwordx4 v48, s[20:23], s39 offen lds
  s_add_u32 m0, s55, 5120
  s_add_u32 s39, s49, 40960
  buffer_load_dwordx4 v49, s[20:23], s39 offen lds
  s_add_u32 m0, s55, 6144
  s_add_u32 s39, s49, 49152
  buffer_load_dwordx4 v48, s[20:23], s39 offen lds
  s_add_u32 m0, s55, 7168
  s_add_u32 s39, s49, 57344
  buffer_load_dwordx4 v49, s[20:23], s39 offen lds
  s_add_u32 s55, s55, 16384
  s_cmp_ge_u32 s55, 49152
  s_cselect_b32 s55, s52, s55
  s_mov_b32 s42, 0
L_Z_ll:
  s_waitcnt vmcnt(8)
  s_barrier
  s_mul_i32 s50, s48, 229376
  s_add_u32 s50, s50, s47
  s_add_u32 s51, s50, s44
  s_add_u32 s50, s50, s43
  s_add_u32 s48, s48, 1
  s_and_b32 s48, s48, 7
  s_add_u32 m0, s53, 0
  s_add_u32 s39, s50, 0
  buffer_load_dwordx4 v50, s[24:27], s39 offen lds
  s_add_u32 m0, s53, 1024
  s_add_u32 s39, s50, 28672
  buffer_load_dwordx4 v51, s[24:27], s39 offen lds
  s_add_u32 m0, s53, 2048
  s_add_u32 s39, s50, 57344
  buffer_load_dwordx4 v50, s[24:27], s39 offen lds
  s_add_u32 m0, s53, 3072
  s_add_u32 s39, s50, 86016
  buffer_load_dwordx4 v51, s[24:27], s39 offen lds
  s_add_u32 m0, s53, 4096
  s_add_u32 s39, s51, 0
  buffer_load_dwordx4 v52, s[24:27], s39 offen lds
  s_add_u32 m0, s53, 5120
  s_add_u32 s39, s51, 57344
  buffer_load_dwordx4 v52, s[24:27], s39 offen lds
  s_add_u32 m0, s53, 6144
  s_add_u32 s39, s51, 64
  buffer_load_dwordx4 v53, s[24:27], s39 offen lds
  s_lshl_b32 s49, s54, 7
  s_add_u32 s49, s49, s46
  s_add_u32 s54, s54, 1
  s_and_b32 s54, s54, 7
  s_add_u32 m0, s55, 0
  s_add_u32 s39, s49, 0
  buffer_load_dwordx4 v48, s[20:23], s39 offen lds
  s_add_u32 m0, s55, 1024
  s_add_u32 s39, s49, 8192
  buffer_load_dwordx4 v49, s[20:23], s39 offen lds
  s_add_u32 m0, s55, 2048
  s_add_u32 s39, s49, 16384
  buffer_load_dwordx4 v48, s[20:23], s39 offen lds
  s_add_u32 m0, s55, 3072
  s_add_u32 s39, s49, 24576
  buffer_load_dwordx4 v49, s[20:23], s39 offen lds
  s_add_u32 m0, s55, 4096
  s_add_u32 s39, s49, 32768
  buffer_load_dwordx4 v48, s[20:23], s39 offen lds
  s_add_u32 m0, s55, 5120
  s_add_u32 s39, s49, 40960
  buffer_load_dwordx4 v49, s[20:23], s39 offen lds
  s_add_u32 m0, s55, 6144
  s_add_u32 s39, s49, 49152
  buffer_load_dwordx4 v48, s[20:23], s39 offen lds
  s_add_u32 m0, s55, 7168
  s_add_u32 s39, s49, 57344
  buffer_load_dwordx4 v49, s[20:23], s39 offen lds
  s_add_u32 s55, s55, 16384
  s_cmp_ge_u32 s55, 49152
  s_cselect_b32 s55, s52, s55
  s_waitcnt vmcnt(8)
  s_barrier
  s_mul_i32 s50, s48, 229376
  s_add_u32 s50, s50, s47
  s_add_u32 s51, s50, s44
  s_add_u32 s50, s50, s43
  s_add_u32 s48, s48, 1
  s_and_b32 s48, s48, 7
  s_add_u32 m0, s53, 14336
  s_add_u32 s39, s50, 0
  buffer_load_dwordx4 v50, s[24:27], s39 offen lds
  s_add_u32 m0, s53, 15360
  s_add_u32 s39, s50, 28672
  buffer_load_dwordx4 v51, s[24:27], s39 offen lds
  s_add_u32 m0, s53, 16384
  s_add_u32 s39, s50, 57344
  buffer_load_dwordx4 v50, s[24:27], s39 offen lds
  s_add_u32 m0, s53, 17408
  s_add_u32 s39, s50, 86016
  buffer_load_dwordx4 v51, s[24:27], s39 offen lds
  s_add_u32 m0, s53, 18432
  s_add_u32 s39, s51, 0
  buffer_load_dwordx4 v52, s[24:27], s39 offen lds
  s_add_u32 m0, s53, 19456
  s_add_u32 s39, s51, 57344
  buffer_load_dwordx4 v52, s[24:27], s39 offen lds
  s_add_u32 m0, s53, 20480
  s_add_u32 s39, s51, 64
  buffer_load_dwordx4 v53, s[24:27], s39 offen lds
  s_cmp_eq_u32 s42, 2
  s_cbranch_scc1 L_Z_lle
  s_lshl_b32 s49, s54, 7
  s_add_u32 s49, s49, s46
  s_add_u32 s54, s54, 1
  s_and_b32 s54, s54, 7
  s_add_u32 m0, s55, 0
  s_add_u32 s39, s49, 0
  buffer_load_dwordx4 v48, s[20:23], s39 offen lds
  s_add_u32 m0, s55, 1024
  s_add_u32 s39, s49, 8192
  buffer_load_dwordx4 v49, s[20:23], s39 offen lds
  s_add_u32 m0, s55, 2048
  s_add_u32 s39, s49, 16384
  buffer_load_dwordx4 v48, s[20:23], s39 offen lds
  s_add_u32 m0, s55, 3072
  s_add_u32 s39, s49, 24576
  buffer_load_dwordx4 v49, s[20:23], s39 offen lds
  s_add_u32 m0, s55, 4096
  s_add_u32 s39, s49, 32768
  buffer_load_dwordx4 v48, s[20:23], s39 offen lds
  s_add_u32 m0, s55, 5120
  s_add_u32 s39, s49, 40960
  buffer_load_dwordx4 v49, s[20:23], s39 offen lds
  s_add_u32 m0, s55, 6144
  s_add_u32 s39, s49, 49152
  buffer_load_dwordx4 v48, s[20:23], s39 offen lds
  s_add_u32 m0, s55, 7168
  s_add_u32 s39, s49, 57344
  buffer_load_dwordx4 v49, s[20:23], s39 offen lds
  s_add_u32 s55, s55, 16384
  s_cmp_ge_u32 s55, 49152
  s_cselect_b32 s55, s52, s55
  s_add_u32 s42, s42, 1
  s_branch L_Z_ll
L_Z_lle:
  s_waitcnt vmcnt(0)
  s_barrier
  s_setprio 3
  s_branch L_Z_hb1
L_Z_aux:
  s_waitcnt lgkmcnt(0)
  s_mov_b32 s20, s10
  s_and_b32 s21, s11, 0xffff
  s_mov_b32 s22, 2097152
  s_mov_b32 s23, 0x20000
  s_mov_b32 s24, s12
  s_and_b32 s25, s13, 0xffff
  s_mov_b32 s26, 1835008
  s_mov_b32 s27, 0x20000
  s_mov_b32 s16, s8
  s_and_b32 s17, s9, 0xffff
  s_mov_b32 s18, 33554432
  s_mov_b32 s19, 0x20000
  s_add_u32 s14, s8, 21757952
  s_addc_u32 s15, s9, 0
  s_load_dword s4, s[14:15], 0
  s_sub_u32 s45, s32, 4
  v_mov_b32 v19, 79872
  v_mov_b32 v20, 0
  ds_write_b32 v19, v20
  s_waitcnt lgkmcnt(0)
  s_mul_i32 s4, s4, 0x9e3779b1
  s_add_u32 s4, s4, 0x7f4a7c15
  s_barrier
  s_barrier
  s_lshl_b32 s36, s33, 11
  s_add_u32 s36, s36, 21495808
  s_sub_u32 s37, s32, 6
  s_lshl_b32 s38, s37, 10
  s_add_u32 s36, s36, s38
  v_lshlrev_b32 v18, 4, v1
  s_lshl_b32 s37, s37, 6
  v_add_u32 v19, s37, v1
  v_lshlrev_b32 v22, 3, v19
  v_lshlrev_b32 v23, 2, v19
  v_add_u32 v22, 77824, v22
  v_add_u32 v23, 78848, v23
  s_mov_b32 s42, 0
  s_barrier
  s_barrier
  s_barrier
  buffer_load_dwordx4 v[60:63], v18, s[16:19], s36 offen sc1
  s_barrier
  s_barrier
  s_waitcnt vmcnt(0)
  v_cmp_ne_u32 vcc, s4, v61
  v_cmp_ne_u32 s[38:39], s4, v63
  s_nop 0
  s_or_b64 vcc, vcc, s[38:39]
  s_cbranch_vccz L_Z_a2
  buffer_load_dwordx4 v[60:63], v18, s[16:19], s36 offen sc1
L_Z_a2:
  s_barrier
L_Z_a1:
  s_waitcnt vmcnt(0)
  v_cmp_ne_u32 vcc, s4, v61
  v_cmp_ne_u32 s[38:39], s4, v63
  s_nop 0
  s_or_b64 vcc, vcc, s[38:39]
  s_cbranch_vccz L_Z_a1d
  s_add_u32 s42, s42, 1
  s_cmp_gt_u32 s42, 0x200000
  s_cbranch_scc1 L_Z_a1d
  s_sleep 2
  buffer_load_dwordx4 v[60:63], v18, s[16:19], s36 offen sc1
  s_branch L_Z_a1
L_Z_a1d:
  v_mov_b32 v61, v62
  ds_write_b64 v22, v[60:61]
  ds_write_b32 v23, v60
  ds_write_b32 v23, v62 offset:512
  s_setprio 3
  s_waitcnt lgkmcnt(0)
L_Z_hb1:
  s_barrier
L_Z_w0d:
  v_lshlrev_b32 v18, 4, v1
  s_lshl_b32 s36, s33, 15
  s_add_u32 s36, s36, 20971520
  v_mov_b32 v16, 79872
  s_cmp_lg_u32 s32, 4
  s_cbranch_scc1 L_Z_gather
  v_add_u32 v19, 32768, v18
  s_lshl_b32 s37, s34, 11
  s_add_u32 s37, s37, s36
  v_mov_b32 v57, s4
  v_mov_b32 v59, s4
  v_mov_b32 v61, s4
  v_mov_b32 v63, s4
L_Z_w1:
  ds_read_b32 v17, v16
  ds_read_b128 v[20:23], v19
  ds_read_b128 v[64:67], v19 offset:1024
  s_waitcnt lgkmcnt(0)
  v_readfirstlane_b32 s40, v17
  s_nop 0
  s_cmp_ge_u32 s40, 4
  s_cbranch_scc1 L_Z_w1d
  s_sleep 1
  s_branch L_Z_w1
L_Z_w1d:
  v_add_f32 v56, v20, v64
  v_add_f32 v58, v21, v65
  v_add_f32 v60, v22, v66
  v_add_f32 v62, v23, v67
  buffer_store_dwordx4 v[56:59], v18, s[16:19], s37 offen sc1
  buffer_store_dwordx4 v[60:63], v18, s[16:19], s37 offen offset:1024 sc1
L_Z_gather:
  s_lshl_b32 s37, s45, 13
  s_add_u32 s36, s36, s37
  s_add_u32 s37, s36, 4096
  s_mov_b32 s42, 0
L_Z_g0:
  s_sleep 2
  ds_read_b32 v17, v16
  s_waitcnt lgkmcnt(0)
  v_readfirstlane_b32 s40, v17
  s_nop 0
  s_cmp_lt_u32 s40, 4
  s_cbranch_scc1 L_Z_g0
  s_sleep 24
L_Z_g1:
  buffer_load_dwordx4 v[72:75], v18, s[16:19], s36 offen offset:0 sc1
  buffer_load_dwordx4 v[76:79], v18, s[16:19], s36 offen offset:1024 sc1
  buffer_load_dwordx4 v[80:83], v18, s[16:19], s36 offen offset:2048 sc1
  buffer_load_dwordx4 v[84:87], v18, s[16:19], s36 offen offset:3072 sc1
  buffer_load_dwordx4 v[88:91], v18, s[16:19], s37 offen offset:0 sc1
  buffer_load_dwordx4 v[92:95], v18, s[16:19], s37 offen offset:1024 sc1
  buffer_load_dwordx4 v[96:99], v18, s[16:19], s37 offen offset:2048 sc1
  buffer_load_dwordx4 v[100:103], v18, s[16:19], s37 offen offset:3072 sc1
  v_mov_b32 v20, 0
  v_mov_b32 v21, s4
  s_add_u32 s42, s42, 1
  s_waitcnt vmcnt(7)
  v_bitop3_b32 v20, v20, v73, v21 bitop3:0xf6
  v_bitop3_b32 v20, v20, v75, v21 bitop3:0xf6
  s_waitcnt vmcnt(6)
  v_bitop3_b32 v20, v20, v77, v21 bitop3:0xf6
  v_bitop3_b32 v20, v20, v79, v21 bitop3:0xf6
  s_waitcnt vmcnt(5)
  v_bitop3_b32 v20, v20, v81, v21 bitop3:0xf6
  v_bitop3_b32 v20, v20, v83, v21 bitop3:0xf6
  s_waitcnt vmcnt(4)
  v_bitop3_b32 v20, v20, v85, v21 bitop3:0xf6
  v_bitop3_b32 v20, v20, v87, v21 bitop3:0xf6
  s_waitcnt vmcnt(3)
  v_bitop3_b32 v20, v20, v89, v21 bitop3:0xf6
  v_bitop3_b32 v20, v20, v91, v21 bitop3:0xf6
  s_waitcnt vmcnt(2)
  v_bitop3_b32 v20, v20, v93, v21 bitop3:0xf6
  v_bitop3_b32 v20, v20, v95, v21 bitop3:0xf6
  s_waitcnt vmcnt(1)
  v_bitop3_b32 v20, v20, v97, v21 bitop3:0xf6
  v_bitop3_b32 v20, v20, v99, v21 bitop3:0xf6
  s_waitcnt vmcnt(0)
  v_bitop3_b32 v20, v20, v101, v21 bitop3:0xf6
  v_bitop3_b32 v20, v20, v103, v21 bitop3:0xf6
  v_cmp_ne_u32 vcc, 0, v20
  s_cmp_gt_u32 s42, 0x100000
  s_cbranch_scc1 L_Z_g2
  s_cbranch_vccnz L_Z_g1
L_Z_g2:
  v_add_f32 v20, v72, v80
  v_add_f32 v20, v20, v88
  v_add_f32 v20, v20, v96
  v_add_f32 v21, v74, v82
  v_add_f32 v21, v21, v90
  v_add_f32 v21, v21, v98
  v_add_f32 v22, v76, v84
  v_add_f32 v22, v22, v92
  v_add_f32 v22, v22, v100
  v_add_f32 v23, v78, v86
  v_add_f32 v23, v23, v94
  v_add_f32 v23, v23, v102
  v_lshlrev_b32 v19, 6, v1
  s_lshl_b32 s36, s45, 3
  s_add_u32 s36, s36, 36864
  v_add_u32 v19, s36, v19
  ds_write_b64 v19, v[20:21]
  ds_write_b64 v19, v[22:23] offset:32
  s_waitcnt lgkmcnt(0)
  s_barrier
  s_lshl_b32 s36, s34, 4
  s_add_u32 s36, s36, s33
  s_lshl_b32 s36, s36, 7
  s_add_u32 s36, s36, 24150016
  v_mov_b32 v16, s4
  s_barrier
  s_cmp_lg_u32 s32, 4
  s_cbranch_scc1 L_Z_done
  s_mov_b64 exec, 1
  buffer_store_dword v16, off, s[16:19], s36 sc1
  s_mov_b64 exec, -1
  s_branch L_Z_done
L_Z_comp:
  s_setprio 1
  s_lshr_b32 s45, s32, 1
  s_and_b32 s46, s32, 1
  v_and_b32 v16, 15, v1
  v_lshrrev_b32 v17, 4, v1
  v_bfe_u32 v18, v1, 1, 3
  v_xor_b32 v18, v18, v17
  v_lshlrev_b32 v18, 4, v18
  v_lshl_add_u32 v18, v16, 7, v18
  s_lshl_b32 s36, s45, 13
  s_lshl_b32 s37, s46, 12
  s_add_u32 s36, s36, s37
  v_add_u32 v2, s36, v18
  v_xor_b32 v3, 4096, v2
  v_xor_b32 v4, 64, v2
  v_xor_b32 v5, 64, v3
  v_and_b32 v19, 3, v1
  v_lshlrev_b32 v18, 3, v19
  v_bfe_u32 v20, v1, 3, 1
  v_lshl_add_u32 v18, v20, 6, v18
  v_bfe_u32 v20, v1, 2, 1
  v_lshl_add_u32 v18, v20, 8, v18
  v_xor_b32 v20, s46, v20
  v_lshl_add_u32 v18, v20, 5, v18
  v_bfe_u32 v20, v1, 4, 1
  v_lshl_add_u32 v18, v20, 7, v18
  v_lshlrev_b32 v21, 3, v19
  v_xor_b32 v20, s46, v20
  v_lshl_add_u32 v21, v20, 5, v21
  v_bfe_u32 v20, v1, 3, 1
  v_lshl_add_u32 v21, v20, 6, v21
  v_bfe_u32 v20, v1, 2, 2
  v_lshl_add_u32 v21, v20, 7, v21
  v_lshl_add_u32 v6, v17, 10, v21
  v_xor_b32 v7, 64, v6
  v_lshrrev_b32 v19, 5, v1
  v_lshl_add_u32 v8, v19, 10, v18
  v_and_b32 v18, 31, v1
  v_lshlrev_b32 v18, 3, v18
  v_lshl_add_u32 v9, v19, 9, v18
  v_add_u32 v6, 49152, v6
  v_add_u32 v7, 49152, v7
  v_add_u32 v8, 49152, v8
  v_add_u32 v9, 49152, v9
  s_mov_b32 s47, 0
  v_mov_b32 v12, 0x3f803f80
  v_mov_b32 v13, 0x3f803f80
  v_mov_b32 v14, 0x3f803f80
  v_mov_b32 v15, 0x3f803f80
  v_mov_b32 v48, 0
  v_mov_b32 v49, 0
  v_mov_b32 v50, 0
  v_mov_b32 v51, 0
  v_mov_b32 v52, 0
  v_mov_b32 v53, 0
  v_mov_b32 v54, 0
  v_mov_b32 v55, 0
  v_mov_b32 v56, 0
  v_mov_b32 v57, 0
  v_mov_b32 v58, 0
  v_mov_b32 v59, 0
  v_mov_b32 v60, 0
  v_mov_b32 v61, 0
  v_mov_b32 v62, 0
  v_mov_b32 v63, 0
  v_mov_b32 v64, 0
  v_mov_b32 v65, 0
  v_mov_b32 v66, 0
  v_mov_b32 v67, 0
  v_mov_b32 v68, 0
  v_mov_b32 v69, 0
  v_mov_b32 v70, 0
  v_mov_b32 v71, 0
  v_mov_b32 v72, 0
  v_mov_b32 v73, 0
  v_mov_b32 v74, 0
  v_mov_b32 v75, 0
  v_mov_b32 v76, 0
  v_mov_b32 v77, 0
  v_mov_b32 v78, 0
  v_mov_b32 v79, 0
  v_mov_b32 v80, 0
  v_mov_b32 v81, 0
  v_mov_b32 v82, 0
  v_mov_b32 v83, 0
  v_mov_b32 v84, 0
  v_mov_b32 v85, 0
  v_mov_b32 v86, 0
  v_mov_b32 v87, 0
  v_mov_b32 v88, 0
  v_mov_b32 v89, 0
  v_mov_b32 v90, 0
  v_mov_b32 v91, 0
  v_mov_b32 v92, 0
  v_mov_b32 v93, 0
  v_mov_b32 v94, 0
  v_mov_b32 v95, 0
  v_mov_b32 v96, 0
  v_mov_b32 v97, 0
  v_mov_b32 v98, 0
  v_mov_b32 v99, 0
  v_mov_b32 v100, 0
  v_mov_b32 v101, 0
  v_mov_b32 v102, 0
  v_mov_b32 v103, 0
  v_mov_b32 v104, 0
  v_mov_b32 v105, 0
  v_mov_b32 v106, 0
  v_mov_b32 v107, 0
  v_mov_b32 v108, 0
  v_mov_b32 v109, 0
  v_mov_b32 v110, 0
  v_mov_b32 v111, 0
  v_mov_b32 v112, 0
  v_mov_b32 v113, 0
  v_mov_b32 v114, 0
  v_mov_b32 v115, 0
  v_mov_b32 v116, 0
  v_mov_b32 v117, 0
  v_mov_b32 v118, 0
  v_mov_b32 v119, 0
  s_waitcnt lgkmcnt(0)
  s_mov_b32 s20, s10
  s_and_b32 s21, s11, 0xffff
  s_mov_b32 s22, 2097152
  s_mov_b32 s23, 0x20000
  s_mov_b32 s24, s12
  s_and_b32 s25, s13, 0xffff
  s_mov_b32 s26, 1835008
  s_mov_b32 s27, 0x20000
  s_mov_b32 s16, s8
  s_and_b32 s17, s9, 0xffff
  s_mov_b32 s18, 33554432
  s_mov_b32 s19, 0x20000
  s_add_u32 s14, s8, 21757952
  s_addc_u32 s15, s9, 0
  s_load_dword s4, s[14:15], 0
  s_waitcnt lgkmcnt(0)
  s_mul_i32 s4, s4, 0x9e3779b1
  s_add_u32 s4, s4, 0x7f4a7c15
  s_mov_b32 s42, 0
  s_barrier
  ds_read_b128 v[16:19], v2 offset:0
  ds_read_b128 v[20:23], v2 offset:2048
  ds_read_b64_tr_b16 v[44:45], v9 offset:6144
  ds_read_b64_tr_b16 v[46:47], v9 offset:6400
  ds_read_b64_tr_b16 v[32:33], v6 offset:0
  ds_read_b64_tr_b16 v[34:35], v6 offset:512
  ds_read_b64_tr_b16 v[36:37], v7 offset:0
  ds_read_b64_tr_b16 v[38:39], v7 offset:512
  ds_read_b64_tr_b16 v[40:41], v8 offset:4096
  ds_read_b64_tr_b16 v[42:43], v8 offset:4608
  ds_read_b128 v[24:27], v3 offset:0
  ds_read_b128 v[28:31], v3 offset:2048
  s_cmp_eq_u32 s45, 1
  s_cbranch_scc1 L_Z_c1
L_Z_c0:
  s_waitcnt lgkmcnt(8)
  v_mfma_f32_16x16x32_bf16 v[112:115], v[44:47], v[16:19], v[112:115]
  v_mfma_f32_16x16x32_bf16 v[116:119], v[44:47], v[20:23], v[116:119]
  v_mfma_f32_16x16x32_bf16 v[60:63], v[44:47], v[12:15], v[60:63]
  s_waitcnt lgkmcnt(6)
  v_mfma_f32_16x16x32_bf16 v[64:67], v[32:35], v[16:19], v[64:67]
  v_mfma_f32_16x16x32_bf16 v[68:71], v[32:35], v[20:23], v[68:71]
  v_mfma_f32_16x16x32_bf16 v[48:51], v[32:35], v[12:15], v[48:51]
  s_waitcnt lgkmcnt(4)
  v_mfma_f32_16x16x32_bf16 v[80:83], v[36:39], v[16:19], v[80:83]
  v_mfma_f32_16x16x32_bf16 v[84:87], v[36:39], v[20:23], v[84:87]
  v_mfma_f32_16x16x32_bf16 v[52:55], v[36:39], v[12:15], v[52:55]
  s_waitcnt lgkmcnt(2)
  v_mfma_f32_16x16x32_bf16 v[96:99], v[40:43], v[16:19], v[96:99]
  v_mfma_f32_16x16x32_bf16 v[100:103], v[40:43], v[20:23], v[100:103]
  v_mfma_f32_16x16x32_bf16 v[56:59], v[40:43], v[12:15], v[56:59]
  s_waitcnt lgkmcnt(0)
  ds_read_b128 v[16:19], v4 offset:0
  ds_read_b128 v[20:23], v4 offset:2048
  ds_read_b64_tr_b16 v[44:45], v9 offset:13312
  ds_read_b64_tr_b16 v[46:47], v9 offset:13568
  v_mfma_f32_16x16x32_bf16 v[72:75], v[32:35], v[24:27], v[72:75]
  v_mfma_f32_16x16x32_bf16 v[76:79], v[32:35], v[28:31], v[76:79]
  ds_read_b64_tr_b16 v[32:33], v6 offset:7168
  ds_read_b64_tr_b16 v[34:35], v6 offset:7680
  v_mfma_f32_16x16x32_bf16 v[88:91], v[36:39], v[24:27], v[88:91]
  v_mfma_f32_16x16x32_bf16 v[92:95], v[36:39], v[28:31], v[92:95]
  ds_read_b64_tr_b16 v[36:37], v7 offset:7168
  ds_read_b64_tr_b16 v[38:39], v7 offset:7680
  v_mfma_f32_16x16x32_bf16 v[104:107], v[40:43], v[24:27], v[104:107]
  v_mfma_f32_16x16x32_bf16 v[108:111], v[40:43], v[28:31], v[108:111]
  ds_read_b64_tr_b16 v[40:41], v8 offset:11264
  ds_read_b64_tr_b16 v[42:43], v8 offset:11776
  ds_read_b128 v[24:27], v5 offset:0
  ds_read_b128 v[28:31], v5 offset:2048
  s_waitcnt lgkmcnt(8)
  v_mfma_f32_16x16x32_bf16 v[112:115], v[44:47], v[16:19], v[112:115]
  v_mfma_f32_16x16x32_bf16 v[116:119], v[44:47], v[20:23], v[116:119]
  s_waitcnt lgkmcnt(6)
  v_mfma_f32_16x16x32_bf16 v[64:67], v[32:35], v[16:19], v[64:67]
  v_mfma_f32_16x16x32_bf16 v[68:71], v[32:35], v[20:23], v[68:71]
  s_waitcnt lgkmcnt(4)
  v_mfma_f32_16x16x32_bf16 v[80:83], v[36:39], v[16:19], v[80:83]
  v_mfma_f32_16x16x32_bf16 v[84:87], v[36:39], v[20:23], v[84:87]
  s_waitcnt lgkmcnt(2)
  v_mfma_f32_16x16x32_bf16 v[96:99], v[40:43], v[16:19], v[96:99]
  v_mfma_f32_16x16x32_bf16 v[100:103], v[40:43], v[20:23], v[100:103]
  s_waitcnt lgkmcnt(0)
  s_add_u32 s47, s47, 1
  s_cmp_eq_u32 s47, 3
  s_cselect_b32 s47, 0, s47
  s_mov_b32 s48, 16384
  s_cmov_b32 s48, 4294934528
  v_add_u32 v2, s48, v2
  v_add_u32 v3, s48, v3
  v_add_u32 v4, s48, v4
  v_add_u32 v5, s48, v5
  s_barrier
  ds_read_b128 v[16:19], v2 offset:0
  ds_read_b128 v[20:23], v2 offset:2048
  ds_read_b64_tr_b16 v[44:45], v9 offset:20480
  ds_read_b64_tr_b16 v[46:47], v9 offset:20736
  v_mfma_f32_16x16x32_bf16 v[72:75], v[32:35], v[24:27], v[72:75]
  v_mfma_f32_16x16x32_bf16 v[76:79], v[32:35], v[28:31], v[76:79]
  ds_read_b64_tr_b16 v[32:33], v6 offset:14336
  ds_read_b64_tr_b16 v[34:35], v6 offset:14848
  v_mfma_f32_16x16x32_bf16 v[88:91], v[36:39], v[24:27], v[88:91]
  v_mfma_f32_16x16x32_bf16 v[92:95], v[36:39], v[28:31], v[92:95]
  ds_read_b64_tr_b16 v[36:37], v7 offset:14336
  ds_read_b64_tr_b16 v[38:39], v7 offset:14848
  v_mfma_f32_16x16x32_bf16 v[104:107], v[40:43], v[24:27], v[104:107]
  v_mfma_f32_16x16x32_bf16 v[108:111], v[40:43], v[28:31], v[108:111]
  ds_read_b64_tr_b16 v[40:41], v8 offset:18432
  ds_read_b64_tr_b16 v[42:43], v8 offset:18944
  ds_read_b128 v[24:27], v3 offset:0
  ds_read_b128 v[28:31], v3 offset:2048
  s_waitcnt lgkmcnt(8)
  v_mfma_f32_16x16x32_bf16 v[112:115], v[44:47], v[16:19], v[112:115]
  v_mfma_f32_16x16x32_bf16 v[116:119], v[44:47], v[20:23], v[116:119]
  v_mfma_f32_16x16x32_bf16 v[60:63], v[44:47], v[12:15], v[60:63]
  s_waitcnt lgkmcnt(6)
  v_mfma_f32_16x16x32_bf16 v[64:67], v[32:35], v[16:19], v[64:67]
  v_mfma_f32_16x16x32_bf16 v[68:71], v[32:35], v[20:23], v[68:71]
  v_mfma_f32_16x16x32_bf16 v[48:51], v[32:35], v[12:15], v[48:51]
  s_waitcnt lgkmcnt(4)
  v_mfma_f32_16x16x32_bf16 v[80:83], v[36:39], v[16:19], v[80:83]
  v_mfma_f32_16x16x32_bf16 v[84:87], v[36:39], v[20:23], v[84:87]
  v_mfma_f32_16x16x32_bf16 v[52:55], v[36:39], v[12:15], v[52:55]
  s_waitcnt lgkmcnt(2)
  v_mfma_f32_16x16x32_bf16 v[96:99], v[40:43], v[16:19], v[96:99]
  v_mfma_f32_16x16x32_bf16 v[100:103], v[40:43], v[20:23], v[100:103]
  v_mfma_f32_16x16x32_bf16 v[56:59], v[40:43], v[12:15], v[56:59]
  s_waitcnt lgkmcnt(0)
  ds_read_b128 v[16:19], v4 offset:0
  ds_read_b128 v[20:23], v4 offset:2048
  ds_read_b64_tr_b16 v[44:45], v9 offset:27648
  ds_read_b64_tr_b16 v[46:47], v9 offset:27904
  v_mfma_f32_16x16x32_bf16 v[72:75], v[32:35], v[24:27], v[72:75]
  v_mfma_f32_16x16x32_bf16 v[76:79], v[32:35], v[28:31], v[76:79]
  ds_read_b64_tr_b16 v[32:33], v6 offset:21504
  ds_read_b64_tr_b16 v[34:35], v6 offset:22016
  v_mfma_f32_16x16x32_bf16 v[88:91], v[36:39], v[24:27], v[88:91]
  v_mfma_f32_16x16x32_bf16 v[92:95], v[36:39], v[28:31], v[92:95]
  ds_read_b64_tr_b16 v[36:37], v7 offset:21504
  ds_read_b64_tr_b16 v[38:39], v7 offset:22016
  v_mfma_f32_16x16x32_bf16 v[104:107], v[40:43], v[24:27], v[104:107]
  v_mfma_f32_16x16x32_bf16 v[108:111], v[40:43], v[28:31], v[108:111]
  ds_read_b64_tr_b16 v[40:41], v8 offset:25600
  ds_read_b64_tr_b16 v[42:43], v8 offset:26112
  ds_read_b128 v[24:27], v5 offset:0
  ds_read_b128 v[28:31], v5 offset:2048
  s_add_u32 s42, s42, 1
  s_cmp_eq_u32 s42, 4
  s_cbranch_scc1 L_Z_cl0
  s_waitcnt lgkmcnt(8)
  v_mfma_f32_16x16x32_bf16 v[112:115], v[44:47], v[16:19], v[112:115]
  v_mfma_f32_16x16x32_bf16 v[116:119], v[44:47], v[20:23], v[116:119]
  s_waitcnt lgkmcnt(6)
  v_mfma_f32_16x16x32_bf16 v[64:67], v[32:35], v[16:19], v[64:67]
  v_mfma_f32_16x16x32_bf16 v[68:71], v[32:35], v[20:23], v[68:71]
  s_waitcnt lgkmcnt(4)
  v_mfma_f32_16x16x32_bf16 v[80:83], v[36:39], v[16:19], v[80:83]
  v_mfma_f32_16x16x32_bf16 v[84:87], v[36:39], v[20:23], v[84:87]
  s_waitcnt lgkmcnt(2)
  v_mfma_f32_16x16x32_bf16 v[96:99], v[40:43], v[16:19], v[96:99]
  v_mfma_f32_16x16x32_bf16 v[100:103], v[40:43], v[20:23], v[100:103]
  s_waitcnt lgkmcnt(0)
  s_add_u32 s47, s47, 1
  s_cmp_eq_u32 s47, 3
  s_cselect_b32 s47, 0, s47
  s_mov_b32 s48, 16384
  s_cmov_b32 s48, 4294934528
  v_add_u32 v2, s48, v2
  v_add_u32 v3, s48, v3
  v_add_u32 v4, s48, v4
  v_add_u32 v5, s48, v5
  s_barrier
  ds_read_b128 v[16:19], v2 offset:0
  ds_read_b128 v[20:23], v2 offset:2048
  ds_read_b64_tr_b16 v[44:45], v9 offset:6144
  ds_read_b64_tr_b16 v[46:47], v9 offset:6400
  v_mfma_f32_16x16x32_bf16 v[72:75], v[32:35], v[24:27], v[72:75]
  v_mfma_f32_16x16x32_bf16 v[76:79], v[32:35], v[28:31], v[76:79]
  ds_read_b64_tr_b16 v[32:33], v6 offset:0
  ds_read_b64_tr_b16 v[34:35], v6 offset:512
  v_mfma_f32_16x16x32_bf16 v[88:91], v[36:39], v[24:27], v[88:91]
  v_mfma_f32_16x16x32_bf16 v[92:95], v[36:39], v[28:31], v[92:95]
  ds_read_b64_tr_b16 v[36:37], v7 offset:0
  ds_read_b64_tr_b16 v[38:39], v7 offset:512
  v_mfma_f32_16x16x32_bf16 v[104:107], v[40:43], v[24:27], v[104:107]
  v_mfma_f32_16x16x32_bf16 v[108:111], v[40:43], v[28:31], v[108:111]
  ds_read_b64_tr_b16 v[40:41], v8 offset:4096
  ds_read_b64_tr_b16 v[42:43], v8 offset:4608
  ds_read_b128 v[24:27], v3 offset:0
  ds_read_b128 v[28:31], v3 offset:2048
  s_branch L_Z_c0
L_Z_cl0:
  s_waitcnt lgkmcnt(8)
  v_mfma_f32_16x16x32_bf16 v[112:115], v[44:47], v[16:19], v[112:115]
  v_mfma_f32_16x16x32_bf16 v[116:119], v[44:47], v[20:23], v[116:119]
  s_waitcnt lgkmcnt(6)
  v_mfma_f32_16x16x32_bf16 v[64:67], v[32:35], v[16:19], v[64:67]
  v_mfma_f32_16x16x32_bf16 v[68:71], v[32:35], v[20:23], v[68:71]
  s_waitcnt lgkmcnt(4)
  v_mfma_f32_16x16x32_bf16 v[80:83], v[36:39], v[16:19], v[80:83]
  v_mfma_f32_16x16x32_bf16 v[84:87], v[36:39], v[20:23], v[84:87]
  s_waitcnt lgkmcnt(2)
  v_mfma_f32_16x16x32_bf16 v[96:99], v[40:43], v[16:19], v[96:99]
  v_mfma_f32_16x16x32_bf16 v[100:103], v[40:43], v[20:23], v[100:103]
  s_waitcnt lgkmcnt(0)
  v_mfma_f32_16x16x32_bf16 v[72:75], v[32:35], v[24:27], v[72:75]
  v_mfma_f32_16x16x32_bf16 v[76:79], v[32:35], v[28:31], v[76:79]
  v_mfma_f32_16x16x32_bf16 v[88:91], v[36:39], v[24:27], v[88:91]
  v_mfma_f32_16x16x32_bf16 v[92:95], v[36:39], v[28:31], v[92:95]
  v_mfma_f32_16x16x32_bf16 v[104:107], v[40:43], v[24:27], v[104:107]
  v_mfma_f32_16x16x32_bf16 v[108:111], v[40:43], v[28:31], v[108:111]
  s_branch L_Z_epi
L_Z_c1:
  s_waitcnt lgkmcnt(8)
  v_mfma_f32_16x16x32_bf16 v[112:115], v[44:47], v[16:19], v[112:115]
  v_mfma_f32_16x16x32_bf16 v[116:119], v[44:47], v[20:23], v[116:119]
  s_waitcnt lgkmcnt(6)
  v_mfma_f32_16x16x32_bf16 v[64:67], v[32:35], v[16:19], v[64:67]
  v_mfma_f32_16x16x32_bf16 v[68:71], v[32:35], v[20:23], v[68:71]
  s_waitcnt lgkmcnt(4)
  v_mfma_f32_16x16x32_bf16 v[80:83], v[36:39], v[16:19], v[80:83]
  v_mfma_f32_16x16x32_bf16 v[84:87], v[36:39], v[20:23], v[84:87]
  s_waitcnt lgkmcnt(2)
  v_mfma_f32_16x16x32_bf16 v[96:99], v[40:43], v[16:19], v[96:99]
  v_mfma_f32_16x16x32_bf16 v[100:103], v[40:43], v[20:23], v[100:103]
  s_waitcnt lgkmcnt(0)
  ds_read_b128 v[16:19], v4 offset:0
  ds_read_b128 v[20:23], v4 offset:2048
  ds_read_b64_tr_b16 v[44:45], v9 offset:13312
  ds_read_b64_tr_b16 v[46:47], v9 offset:13568
  v_mfma_f32_16x16x32_bf16 v[72:75], v[32:35], v[24:27], v[72:75]
  v_mfma_f32_16x16x32_bf16 v[76:79], v[32:35], v[28:31], v[76:79]
  ds_read_b64_tr_b16 v[32:33], v6 offset:7168
  ds_read_b64_tr_b16 v[34:35], v6 offset:7680
  v_mfma_f32_16x16x32_bf16 v[88:91], v[36:39], v[24:27], v[88:91]
  v_mfma_f32_16x16x32_bf16 v[92:95], v[36:39], v[28:31], v[92:95]
  ds_read_b64_tr_b16 v[36:37], v7 offset:7168
  ds_read_b64_tr_b16 v[38:39], v7 offset:7680
  v_mfma_f32_16x16x32_bf16 v[104:107], v[40:43], v[24:27], v[104:107]
  v_mfma_f32_16x16x32_bf16 v[108:111], v[40:43], v[28:31], v[108:111]
  ds_read_b64_tr_b16 v[40:41], v8 offset:11264
  ds_read_b64_tr_b16 v[42:43], v8 offset:11776
  ds_read_b128 v[24:27], v5 offset:0
  ds_read_b128 v[28:31], v5 offset:2048
  s_waitcnt lgkmcnt(8)
  v_mfma_f32_16x16x32_bf16 v[112:115], v[44:47], v[16:19], v[112:115]
  v_mfma_f32_16x16x32_bf16 v[116:119], v[44:47], v[20:23], v[116:119]
  v_mfma_f32_16x16x32_bf16 v[60:63], v[44:47], v[12:15], v[60:63]
  s_waitcnt lgkmcnt(6)
  v_mfma_f32_16x16x32_bf16 v[64:67], v[32:35], v[16:19], v[64:67]
  v_mfma_f32_16x16x32_bf16 v[68:71], v[32:35], v[20:23], v[68:71]
  v_mfma_f32_16x16x32_bf16 v[48:51], v[32:35], v[12:15], v[48:51]
  s_waitcnt lgkmcnt(4)
  v_mfma_f32_16x16x32_bf16 v[80:83], v[36:39], v[16:19], v[80:83]
  v_mfma_f32_16x16x32_bf16 v[84:87], v[36:39], v[20:23], v[84:87]
  v_mfma_f32_16x16x32_bf16 v[52:55], v[36:39], v[12:15], v[52:55]
  s_waitcnt lgkmcnt(2)
  v_mfma_f32_16x16x32_bf16 v[96:99], v[40:43], v[16:19], v[96:99]
  v_mfma_f32_16x16x32_bf16 v[100:103], v[40:43], v[20:23], v[100:103]
  v_mfma_f32_16x16x32_bf16 v[56:59], v[40:43], v[12:15], v[56:59]
  s_waitcnt lgkmcnt(0)
  s_add_u32 s47, s47, 1
  s_cmp_eq_u32 s47, 3
  s_cselect_b32 s47, 0, s47
  s_mov_b32 s48, 16384
  s_cmov_b32 s48, 4294934528
  v_add_u32 v2, s48, v2
  v_add_u32 v3, s48, v3
  v_add_u32 v4, s48, v4
  v_add_u32 v5, s48, v5
  s_barrier
  ds_read_b128 v[16:19], v2 offset:0
  ds_read_b128 v[20:23], v2 offset:2048
  ds_read_b64_tr_b16 v[44:45], v9 offset:20480
  ds_read_b64_tr_b16 v[46:47], v9 offset:20736
  v_mfma_f32_16x16x32_bf16 v[72:75], v[32:35], v[24:27], v[72:75]
  v_mfma_f32_16x16x32_bf16 v[76:79], v[32:35], v[28:31], v[76:79]
  ds_read_b64_tr_b16 v[32:33], v6 offset:14336
  ds_read_b64_tr_b16 v[34:35], v6 offset:14848
  v_mfma_f32_16x16x32_bf16 v[88:91], v[36:39], v[24:27], v[88:91]
  v_mfma_f32_16x16x32_bf16 v[92:95], v[36:39], v[28:31], v[92:95]
  ds_read_b64_tr_b16 v[36:37], v7 offset:14336
  ds_read_b64_tr_b16 v[38:39], v7 offset:14848
  v_mfma_f32_16x16x32_bf16 v[104:107], v[40:43], v[24:27], v[104:107]
  v_mfma_f32_16x16x32_bf16 v[108:111], v[40:43], v[28:31], v[108:111]
  ds_read_b64_tr_b16 v[40:41], v8 offset:18432
  ds_read_b64_tr_b16 v[42:43], v8 offset:18944
  ds_read_b128 v[24:27], v3 offset:0
  ds_read_b128 v[28:31], v3 offset:2048
  s_waitcnt lgkmcnt(8)
  v_mfma_f32_16x16x32_bf16 v[112:115], v[44:47], v[16:19], v[112:115]
  v_mfma_f32_16x16x32_bf16 v[116:119], v[44:47], v[20:23], v[116:119]
  s_waitcnt lgkmcnt(6)
  v_mfma_f32_16x16x32_bf16 v[64:67], v[32:35], v[16:19], v[64:67]
  v_mfma_f32_16x16x32_bf16 v[68:71], v[32:35], v[20:23], v[68:71]
  s_waitcnt lgkmcnt(4)
  v_mfma_f32_16x16x32_bf16 v[80:83], v[36:39], v[16:19], v[80:83]
  v_mfma_f32_16x16x32_bf16 v[84:87], v[36:39], v[20:23], v[84:87]
  s_waitcnt lgkmcnt(2)
  v_mfma_f32_16x16x32_bf16 v[96:99], v[40:43], v[16:19], v[96:99]
  v_mfma_f32_16x16x32_bf16 v[100:103], v[40:43], v[20:23], v[100:103]
  s_waitcnt lgkmcnt(0)
  ds_read_b128 v[16:19], v4 offset:0
  ds_read_b128 v[20:23], v4 offset:2048
  ds_read_b64_tr_b16 v[44:45], v9 offset:27648
  ds_read_b64_tr_b16 v[46:47], v9 offset:27904
  v_mfma_f32_16x16x32_bf16 v[72:75], v[32:35], v[24:27], v[72:75]
  v_mfma_f32_16x16x32_bf16 v[76:79], v[32:35], v[28:31], v[76:79]
  ds_read_b64_tr_b16 v[32:33], v6 offset:21504
  ds_read_b64_tr_b16 v[34:35], v6 offset:22016
  v_mfma_f32_16x16x32_bf16 v[88:91], v[36:39], v[24:27], v[88:91]
  v_mfma_f32_16x16x32_bf16 v[92:95], v[36:39], v[28:31], v[92:95]
  ds_read_b64_tr_b16 v[36:37], v7 offset:21504
  ds_read_b64_tr_b16 v[38:39], v7 offset:22016
  v_mfma_f32_16x16x32_bf16 v[104:107], v[40:43], v[24:27], v[104:107]
  v_mfma_f32_16x16x32_bf16 v[108:111], v[40:43], v[28:31], v[108:111]
  ds_read_b64_tr_b16 v[40:41], v8 offset:25600
  ds_read_b64_tr_b16 v[42:43], v8 offset:26112
  ds_read_b128 v[24:27], v5 offset:0
  ds_read_b128 v[28:31], v5 offset:2048
  s_add_u32 s42, s42, 1
  s_cmp_eq_u32 s42, 4
  s_cbranch_scc1 L_Z_cl1
  s_waitcnt lgkmcnt(8)
  v_mfma_f32_16x16x32_bf16 v[112:115], v[44:47], v[16:19], v[112:115]
  v_mfma_f32_16x16x32_bf16 v[116:119], v[44:47], v[20:23], v[116:119]
  v_mfma_f32_16x16x32_bf16 v[60:63], v[44:47], v[12:15], v[60:63]
  s_waitcnt lgkmcnt(6)
  v_mfma_f32_16x16x32_bf16 v[64:67], v[32:35], v[16:19], v[64:67]
  v_mfma_f32_16x16x32_bf16 v[68:71], v[32:35], v[20:23], v[68:71]
  v_mfma_f32_16x16x32_bf16 v[48:51], v[32:35], v[12:15], v[48:51]
  s_waitcnt lgkmcnt(4)
  v_mfma_f32_16x16x32_bf16 v[80:83], v[36:39], v[16:19], v[80:83]
  v_mfma_f32_16x16x32_bf16 v[84:87], v[36:39], v[20:23], v[84:87]
  v_mfma_f32_16x16x32_bf16 v[52:55], v[36:39], v[12:15], v[52:55]
  s_waitcnt lgkmcnt(2)
  v_mfma_f32_16x16x32_bf16 v[96:99], v[40:43], v[16:19], v[96:99]
  v_mfma_f32_16x16x32_bf16 v[100:103], v[40:43], v[20:23], v[100:103]
  v_mfma_f32_16x16x32_bf16 v[56:59], v[40:43], v[12:15], v[56:59]
  s_waitcnt lgkmcnt(0)
  s_add_u32 s47, s47, 1
  s_cmp_eq_u32 s47, 3
  s_cselect_b32 s47, 0, s47
  s_mov_b32 s48, 16384
  s_cmov_b32 s48, 4294934528
  v_add_u32 v2, s48, v2
  v_add_u32 v3, s48, v3
  v_add_u32 v4, s48, v4
  v_add_u32 v5, s48, v5
  s_barrier
  ds_read_b128 v[16:19], v2 offset:0
  ds_read_b128 v[20:23], v2 offset:2048
  ds_read_b64_tr_b16 v[44:45], v9 offset:6144
  ds_read_b64_tr_b16 v[46:47], v9 offset:6400
  v_mfma_f32_16x16x32_bf16 v[72:75], v[32:35], v[24:27], v[72:75]
  v_mfma_f32_16x16x32_bf16 v[76:79], v[32:35], v[28:31], v[76:79]
  ds_read_b64_tr_b16 v[32:33], v6 offset:0
  ds_read_b64_tr_b16 v[34:35], v6 offset:512
  v_mfma_f32_16x16x32_bf16 v[88:91], v[36:39], v[24:27], v[88:91]
  v_mfma_f32_16x16x32_bf16 v[92:95], v[36:39], v[28:31], v[92:95]
  ds_read_b64_tr_b16 v[36:37], v7 offset:0
  ds_read_b64_tr_b16 v[38:39], v7 offset:512
  v_mfma_f32_16x16x32_bf16 v[104:107], v[40:43], v[24:27], v[104:107]
  v_mfma_f32_16x16x32_bf16 v[108:111], v[40:43], v[28:31], v[108:111]
  ds_read_b64_tr_b16 v[40:41], v8 offset:4096
  ds_read_b64_tr_b16 v[42:43], v8 offset:4608
  ds_read_b128 v[24:27], v3 offset:0
  ds_read_b128 v[28:31], v3 offset:2048
  s_branch L_Z_c1
L_Z_cl1:
  s_waitcnt lgkmcnt(8)
  v_mfma_f32_16x16x32_bf16 v[112:115], v[44:47], v[16:19], v[112:115]
  v_mfma_f32_16x16x32_bf16 v[116:119], v[44:47], v[20:23], v[116:119]
  v_mfma_f32_16x16x32_bf16 v[60:63], v[44:47], v[12:15], v[60:63]
  s_waitcnt lgkmcnt(6)
  v_mfma_f32_16x16x32_bf16 v[64:67], v[32:35], v[16:19], v[64:67]
  v_mfma_f32_16x16x32_bf16 v[68:71], v[32:35], v[20:23], v[68:71]
  v_mfma_f32_16x16x32_bf16 v[48:51], v[32:35], v[12:15], v[48:51]
  s_waitcnt lgkmcnt(4)
  v_mfma_f32_16x16x32_bf16 v[80:83], v[36:39], v[16:19], v[80:83]
  v_mfma_f32_16x16x32_bf16 v[84:87], v[36:39], v[20:23], v[84:87]
  v_mfma_f32_16x16x32_bf16 v[52:55], v[36:39], v[12:15], v[52:55]
  s_waitcnt lgkmcnt(2)
  v_mfma_f32_16x16x32_bf16 v[96:99], v[40:43], v[16:19], v[96:99]
  v_mfma_f32_16x16x32_bf16 v[100:103], v[40:43], v[20:23], v[100:103]
  v_mfma_f32_16x16x32_bf16 v[56:59], v[40:43], v[12:15], v[56:59]
  s_waitcnt lgkmcnt(0)
  v_mfma_f32_16x16x32_bf16 v[72:75], v[32:35], v[24:27], v[72:75]
  v_mfma_f32_16x16x32_bf16 v[76:79], v[32:35], v[28:31], v[76:79]
  v_mfma_f32_16x16x32_bf16 v[88:91], v[36:39], v[24:27], v[88:91]
  v_mfma_f32_16x16x32_bf16 v[92:95], v[36:39], v[28:31], v[92:95]
  v_mfma_f32_16x16x32_bf16 v[104:107], v[40:43], v[24:27], v[104:107]
  v_mfma_f32_16x16x32_bf16 v[108:111], v[40:43], v[28:31], v[108:111]
L_Z_epi:
  s_setprio 3
  s_lshl_b32 s49, s45, 2
  s_lshl_b32 s36, s46, 1
  s_add_u32 s49, s49, s36
  s_xor_b32 s50, s49, 2
  s_lshl_b32 s36, s46, 13
  s_lshl_b32 s37, s45, 12
  s_add_u32 s36, s36, s37
  v_lshlrev_b32 v4, 4, v1
  v_add_u32 v8, s36, v4
  v_xor_b32 v9, 4096, v8
  v_and_b32 v24, 15, v1
  v_lshrrev_b32 v25, 4, v1
  v_lshlrev_b32 v26, 3, v24
  s_lshl_b32 s36, s49, 7
  s_lshl_b32 s37, s50, 7
  v_add_u32 v2, s36, v26
  v_add_u32 v3, s37, v26
  v_add_u32 v30, 77824, v2
  v_add_u32 v31, 77824, v3
  s_lshl_b32 s36, s33, 3
  s_add_u32 s37, s36, s49
  s_add_u32 s38, s36, s50
  ds_write_b128 v8, v[48:51] offset:0
  ds_write_b128 v8, v[52:55] offset:1024
  ds_write_b128 v8, v[56:59] offset:2048
  ds_write_b128 v8, v[60:63] offset:3072
  v_lshrrev_b32 v27, 5, v1
  v_bfe_u32 v28, v1, 4, 1
  v_mul_u32_u24 v4, 28672, v28
  v_lshl_add_u32 v4, v27, 8, v4
  v_lshl_add_u32 v4, v24, 4, v4
  v_lshlrev_b32 v27, 6, v27
  v_xor_b32 v7, v4, v27
  v_mov_b32 v12, 0xc0135761
  v_mov_b32 v13, 0xc0135761
  s_mov_b32 s58, 0xbdd2d3e8
  s_mov_b32 s59, 0xbdd2d3e8
  s_mov_b32 s60, 1.0
  s_mov_b32 s61, 1.0
  s_mul_i32 s39, s37, 28672
  s_mul_i32 s40, s38, 28672
  s_cmp_lt_u32 s34, 8
  s_mov_b32 s52, 6291456
  s_cmov_b32 s52, 10457088
  s_mov_b32 s54, 10457088
  s_cmov_b32 s54, 6291456
  s_lshl_b32 s41, s43, 4
  s_add_u32 s52, s52, s41
  s_lshl_b32 s41, s44, 4
  s_add_u32 s54, s54, s41
  s_add_u32 s53, s52, s40
  s_add_u32 s52, s52, s39
  s_add_u32 s55, s54, s40
  s_add_u32 s54, s54, s39
  s_lshl_b32 s36, s46, 9
  v_add_u32 v5, s36, v4
  s_and_b32 s37, s34, 1
  s_cmp_lt_u32 s34, 8
  s_cselect_b32 s38, 0, s37
  s_xor_b32 s38, s38, s46
  s_lshl_b32 s38, s38, 7
  s_lshl_b32 s37, s37, 7
  v_xor_b32 v6, s38, v7
  v_add_u32 v6, s36, v6
  v_xor_b32 v7, s37, v7
  s_waitcnt lgkmcnt(0)
  s_barrier
  ds_read_b128 v[32:35], v9 offset:0
  ds_read_b128 v[36:39], v9 offset:1024
  ds_read_b128 v[40:43], v9 offset:2048
  ds_read_b128 v[44:47], v9 offset:3072
  ds_read_b64 v[16:17], v30 offset:0
  ds_read_b64 v[18:19], v30 offset:128
  ds_read_b64 v[20:21], v31 offset:0
  ds_read_b64 v[22:23], v31 offset:128
  s_waitcnt lgkmcnt(0)
  v_add_f32 v48, v48, v32
  v_add_f32 v49, v49, v33
  v_add_f32 v50, v50, v34
  v_add_f32 v51, v51, v35
  v_add_f32 v52, v52, v36
  v_add_f32 v53, v53, v37
  v_add_f32 v54, v54, v38
  v_add_f32 v55, v55, v39
  v_add_f32 v56, v56, v40
  v_add_f32 v57, v57, v41
  v_add_f32 v58, v58, v42
  v_add_f32 v59, v59, v43
  v_add_f32 v60, v60, v44
  v_add_f32 v61, v61, v45
  v_add_f32 v62, v62, v46
  v_add_f32 v63, v63, v47
  s_cmp_lt_u32 s34, 8
  s_cbranch_scc0 L_Z_e1
L_Z_e0:
  v_mul_f32 v24, v48, v17
  v_mul_f32 v26, v49, v17
  v_mul_f32 v28, v50, v17
  v_mul_f32 v30, v51, v17
  v_mul_f32 v32, v48, v19
  v_mul_f32 v34, v49, v19
  v_mul_f32 v36, v50, v19
  v_mul_f32 v38, v51, v19
  v_fma_f32 v64, v64, v16, v24
  v_fma_f32 v65, v65, v16, v26
  v_fma_f32 v66, v66, v16, v28
  v_fma_f32 v67, v67, v16, v30
  v_fma_f32 v68, v68, v18, v32
  v_fma_f32 v69, v69, v18, v34
  v_fma_f32 v70, v70, v18, v36
  v_fma_f32 v71, v71, v18, v38
  v_mul_f32 v24, v64, v64
  v_mul_f32 v26, v65, v65
  v_mul_f32 v28, v66, v66
  v_mul_f32 v30, v67, v67
  v_mul_f32 v32, v68, v68
  v_mul_f32 v34, v69, v69
  v_mul_f32 v36, v70, v70
  v_mul_f32 v38, v71, v71
  v_fmamk_f32 v24, v24, 0xbdd2d3e8, v12
  v_fmamk_f32 v26, v26, 0xbdd2d3e8, v12
  v_fmamk_f32 v28, v28, 0xbdd2d3e8, v12
  v_fmamk_f32 v30, v30, 0xbdd2d3e8, v12
  v_fmamk_f32 v32, v32, 0xbdd2d3e8, v12
  v_fmamk_f32 v34, v34, 0xbdd2d3e8, v12
  v_fmamk_f32 v36, v36, 0xbdd2d3e8, v12
  v_fmamk_f32 v38, v38, 0xbdd2d3e8, v12
  v_mul_f32 v24, v64, v24
  v_mul_f32 v26, v65, v26
  v_mul_f32 v28, v66, v28
  v_mul_f32 v30, v67, v30
  v_mul_f32 v32, v68, v32
  v_mul_f32 v34, v69, v34
  v_mul_f32 v36, v70, v36
  v_mul_f32 v38, v71, v38
  v_exp_f32 v25, v24
  v_exp_f32 v27, v26
  v_exp_f32 v29, v28
  v_exp_f32 v31, v30
  v_exp_f32 v33, v32
  v_exp_f32 v35, v34
  v_exp_f32 v37, v36
  v_exp_f32 v39, v38
  v_add_f32 v25, 1.0, v25
  v_add_f32 v27, 1.0, v27
  v_add_f32 v29, 1.0, v29
  v_add_f32 v31, 1.0, v31
  v_add_f32 v33, 1.0, v33
  v_add_f32 v35, 1.0, v35
  v_add_f32 v37, 1.0, v37
  v_add_f32 v39, 1.0, v39
  v_rcp_f32 v25, v25
  v_rcp_f32 v27, v27
  v_rcp_f32 v29, v29
  v_rcp_f32 v31, v31
  v_rcp_f32 v33, v33
  v_rcp_f32 v35, v35
  v_rcp_f32 v37, v37
  v_rcp_f32 v39, v39
  v_mul_f32 v64, v64, v25
  v_mul_f32 v65, v65, v27
  v_mul_f32 v66, v66, v29
  v_mul_f32 v67, v67, v31
  v_mul_f32 v68, v68, v33
  v_mul_f32 v69, v69, v35
  v_mul_f32 v70, v70, v37
  v_mul_f32 v71, v71, v39
  v_add_f32 v40, v64, v66
  v_add_f32 v41, v65, v67
  v_mul_f32 v44, v64, v64
  v_mul_f32 v45, v65, v65
  v_add_f32 v42, v68, v70
  v_add_f32 v43, v69, v71
  v_mul_f32 v46, v68, v68
  v_mul_f32 v47, v69, v69
  v_fma_f32 v44, v66, v66, v44
  v_fma_f32 v45, v67, v67, v45
  v_fma_f32 v46, v70, v70, v46
  v_fma_f32 v47, v71, v71, v47
  v_mul_f32 v24, v52, v17
  v_mul_f32 v26, v53, v17
  v_mul_f32 v28, v54, v17
  v_mul_f32 v30, v55, v17
  v_mul_f32 v32, v52, v19
  v_mul_f32 v34, v53, v19
  v_mul_f32 v36, v54, v19
  v_mul_f32 v38, v55, v19
  v_fma_f32 v80, v80, v16, v24
  v_fma_f32 v81, v81, v16, v26
  v_fma_f32 v82, v82, v16, v28
  v_fma_f32 v83, v83, v16, v30
  v_fma_f32 v84, v84, v18, v32
  v_fma_f32 v85, v85, v18, v34
  v_fma_f32 v86, v86, v18, v36
  v_fma_f32 v87, v87, v18, v38
  v_mul_f32 v24, v80, v80
  v_mul_f32 v26, v81, v81
  v_mul_f32 v28, v82, v82
  v_mul_f32 v30, v83, v83
  v_mul_f32 v32, v84, v84
  v_mul_f32 v34, v85, v85
  v_mul_f32 v36, v86, v86
  v_mul_f32 v38, v87, v87
  v_fmamk_f32 v24, v24, 0xbdd2d3e8, v12
  v_fmamk_f32 v26, v26, 0xbdd2d3e8, v12
  v_fmamk_f32 v28, v28, 0xbdd2d3e8, v12
  v_fmamk_f32 v30, v30, 0xbdd2d3e8, v12
  v_fmamk_f32 v32, v32, 0xbdd2d3e8, v12
  v_fmamk_f32 v34, v34, 0xbdd2d3e8, v12
  v_fmamk_f32 v36, v36, 0xbdd2d3e8, v12
  v_fmamk_f32 v38, v38, 0xbdd2d3e8, v12
  v_mul_f32 v24, v80, v24
  v_mul_f32 v26, v81, v26
  v_mul_f32 v28, v82, v28
  v_mul_f32 v30, v83, v30
  v_mul_f32 v32, v84, v32
  v_mul_f32 v34, v85, v34
  v_mul_f32 v36, v86, v36
  v_mul_f32 v38, v87, v38
  v_exp_f32 v25, v24
  v_exp_f32 v27, v26
  v_exp_f32 v29, v28
  v_exp_f32 v31, v30
  v_exp_f32 v33, v32
  v_exp_f32 v35, v34
  v_exp_f32 v37, v36
  v_exp_f32 v39, v38
  v_add_f32 v25, 1.0, v25
  v_add_f32 v27, 1.0, v27
  v_add_f32 v29, 1.0, v29
  v_add_f32 v31, 1.0, v31
  v_add_f32 v33, 1.0, v33
  v_add_f32 v35, 1.0, v35
  v_add_f32 v37, 1.0, v37
  v_add_f32 v39, 1.0, v39
  v_rcp_f32 v25, v25
  v_rcp_f32 v27, v27
  v_rcp_f32 v29, v29
  v_rcp_f32 v31, v31
  v_rcp_f32 v33, v33
  v_rcp_f32 v35, v35
  v_rcp_f32 v37, v37
  v_rcp_f32 v39, v39
  v_mul_f32 v80, v80, v25
  v_mul_f32 v81, v81, v27
  v_mul_f32 v82, v82, v29
  v_mul_f32 v83, v83, v31
  v_mul_f32 v84, v84, v33
  v_mul_f32 v85, v85, v35
  v_mul_f32 v86, v86, v37
  v_mul_f32 v87, v87, v39
  v_add_f32 v40, v40, v80
  v_add_f32 v41, v41, v81
  v_fma_f32 v44, v80, v80, v44
  v_fma_f32 v45, v81, v81, v45
  v_add_f32 v42, v42, v84
  v_add_f32 v43, v43, v85
  v_fma_f32 v46, v84, v84, v46
  v_fma_f32 v47, v85, v85, v47
  v_add_f32 v40, v40, v82
  v_add_f32 v41, v41, v83
  v_fma_f32 v44, v82, v82, v44
  v_fma_f32 v45, v83, v83, v45
  v_add_f32 v42, v42, v86
  v_add_f32 v43, v43, v87
  v_fma_f32 v46, v86, v86, v46
  v_fma_f32 v47, v87, v87, v47
  v_add_f32 v120, v40, v41
  v_add_f32 v10, v44, v45
  v_add_f32 v121, v42, v43
  v_add_f32 v11, v46, v47
  v_mul_f32 v24, v48, v21
  v_mul_f32 v26, v49, v21
  v_mul_f32 v28, v50, v21
  v_mul_f32 v30, v51, v21
  v_mul_f32 v32, v48, v23
  v_mul_f32 v34, v49, v23
  v_mul_f32 v36, v50, v23
  v_mul_f32 v38, v51, v23
  v_fma_f32 v72, v72, v20, v24
  v_fma_f32 v73, v73, v20, v26
  v_fma_f32 v74, v74, v20, v28
  v_fma_f32 v75, v75, v20, v30
  v_fma_f32 v76, v76, v22, v32
  v_fma_f32 v77, v77, v22, v34
  v_fma_f32 v78, v78, v22, v36
  v_fma_f32 v79, v79, v22, v38
  v_mul_f32 v24, v72, v72
  v_mul_f32 v26, v73, v73
  v_mul_f32 v28, v74, v74
  v_mul_f32 v30, v75, v75
  v_mul_f32 v32, v76, v76
  v_mul_f32 v34, v77, v77
  v_mul_f32 v36, v78, v78
  v_mul_f32 v38, v79, v79
  v_fmamk_f32 v24, v24, 0xbdd2d3e8, v12
  v_fmamk_f32 v26, v26, 0xbdd2d3e8, v12
  v_fmamk_f32 v28, v28, 0xbdd2d3e8, v12
  v_fmamk_f32 v30, v30, 0xbdd2d3e8, v12
  v_fmamk_f32 v32, v32, 0xbdd2d3e8, v12
  v_fmamk_f32 v34, v34, 0xbdd2d3e8, v12
  v_fmamk_f32 v36, v36, 0xbdd2d3e8, v12
  v_fmamk_f32 v38, v38, 0xbdd2d3e8, v12
  v_mul_f32 v24, v72, v24
  v_mul_f32 v26, v73, v26
  v_mul_f32 v28, v74, v28
  v_mul_f32 v30, v75, v30
  v_mul_f32 v32, v76, v32
  v_mul_f32 v34, v77, v34
  v_mul_f32 v36, v78, v36
  v_mul_f32 v38, v79, v38
  v_exp_f32 v25, v24
  v_exp_f32 v27, v26
  v_exp_f32 v29, v28
  v_exp_f32 v31, v30
  v_exp_f32 v33, v32
  v_exp_f32 v35, v34
  v_exp_f32 v37, v36
  v_exp_f32 v39, v38
  v_add_f32 v25, 1.0, v25
  v_add_f32 v27, 1.0, v27
  v_add_f32 v29, 1.0, v29
  v_add_f32 v31, 1.0, v31
  v_add_f32 v33, 1.0, v33
  v_add_f32 v35, 1.0, v35
  v_add_f32 v37, 1.0, v37
  v_add_f32 v39, 1.0, v39
  v_rcp_f32 v25, v25
  v_rcp_f32 v27, v27
  v_rcp_f32 v29, v29
  v_rcp_f32 v31, v31
  v_rcp_f32 v33, v33
  v_rcp_f32 v35, v35
  v_rcp_f32 v37, v37
  v_rcp_f32 v39, v39
  v_mul_f32 v72, v72, v25
  v_mul_f32 v73, v73, v27
  v_mul_f32 v74, v74, v29
  v_mul_f32 v75, v75, v31
  v_mul_f32 v76, v76, v33
  v_mul_f32 v77, v77, v35
  v_mul_f32 v78, v78, v37
  v_mul_f32 v79, v79, v39
  v_add_f32 v40, v72, v74
  v_add_f32 v41, v73, v75
  v_mul_f32 v44, v72, v72
  v_mul_f32 v45, v73, v73
  v_add_f32 v42, v76, v78
  v_add_f32 v43, v77, v79
  v_mul_f32 v46, v76, v76
  v_mul_f32 v47, v77, v77
  v_fma_f32 v44, v74, v74, v44
  v_fma_f32 v45, v75, v75, v45
  v_fma_f32 v46, v78, v78, v46
  v_fma_f32 v47, v79, v79, v47
  v_mul_f32 v24, v52, v21
  v_mul_f32 v26, v53, v21
  v_mul_f32 v28, v54, v21
  v_mul_f32 v30, v55, v21
  v_mul_f32 v32, v52, v23
  v_mul_f32 v34, v53, v23
  v_mul_f32 v36, v54, v23
  v_mul_f32 v38, v55, v23
  v_fma_f32 v88, v88, v20, v24
  v_fma_f32 v89, v89, v20, v26
  v_fma_f32 v90, v90, v20, v28
  v_fma_f32 v91, v91, v20, v30
  v_fma_f32 v92, v92, v22, v32
  v_fma_f32 v93, v93, v22, v34
  v_fma_f32 v94, v94, v22, v36
  v_fma_f32 v95, v95, v22, v38
  v_mul_f32 v24, v88, v88
  v_mul_f32 v26, v89, v89
  v_mul_f32 v28, v90, v90
  v_mul_f32 v30, v91, v91
  v_mul_f32 v32, v92, v92
  v_mul_f32 v34, v93, v93
  v_mul_f32 v36, v94, v94
  v_mul_f32 v38, v95, v95
  v_fmamk_f32 v24, v24, 0xbdd2d3e8, v12
  v_fmamk_f32 v26, v26, 0xbdd2d3e8, v12
  v_fmamk_f32 v28, v28, 0xbdd2d3e8, v12
  v_fmamk_f32 v30, v30, 0xbdd2d3e8, v12
  v_fmamk_f32 v32, v32, 0xbdd2d3e8, v12
  v_fmamk_f32 v34, v34, 0xbdd2d3e8, v12
  v_fmamk_f32 v36, v36, 0xbdd2d3e8, v12
  v_fmamk_f32 v38, v38, 0xbdd2d3e8, v12
  v_mul_f32 v24, v88, v24
  v_mul_f32 v26, v89, v26
  v_mul_f32 v28, v90, v28
  v_mul_f32 v30, v91, v30
  v_mul_f32 v32, v92, v32
  v_mul_f32 v34, v93, v34
  v_mul_f32 v36, v94, v36
  v_mul_f32 v38, v95, v38
  v_exp_f32 v25, v24
  v_exp_f32 v27, v26
  v_exp_f32 v29, v28
  v_exp_f32 v31, v30
  v_exp_f32 v33, v32
  v_exp_f32 v35, v34
  v_exp_f32 v37, v36
  v_exp_f32 v39, v38
  v_add_f32 v25, 1.0, v25
  v_add_f32 v27, 1.0, v27
  v_add_f32 v29, 1.0, v29
  v_add_f32 v31, 1.0, v31
  v_add_f32 v33, 1.0, v33
  v_add_f32 v35, 1.0, v35
  v_add_f32 v37, 1.0, v37
  v_add_f32 v39, 1.0, v39
  v_rcp_f32 v25, v25
  v_rcp_f32 v27, v27
  v_rcp_f32 v29, v29
  v_rcp_f32 v31, v31
  v_rcp_f32 v33, v33
  v_rcp_f32 v35, v35
  v_rcp_f32 v37, v37
  v_rcp_f32 v39, v39
  v_mul_f32 v88, v88, v25
  v_mul_f32 v89, v89, v27
  v_mul_f32 v90, v90, v29
  v_mul_f32 v91, v91, v31
  v_mul_f32 v92, v92, v33
  v_mul_f32 v93, v93, v35
  v_mul_f32 v94, v94, v37
  v_mul_f32 v95, v95, v39
  v_add_f32 v40, v40, v88
  v_add_f32 v41, v41, v89
  v_fma_f32 v44, v88, v88, v44
  v_fma_f32 v45, v89, v89, v45
  v_add_f32 v42, v42, v92
  v_add_f32 v43, v43, v93
  v_fma_f32 v46, v92, v92, v46
  v_fma_f32 v47, v93, v93, v47
  v_add_f32 v40, v40, v90
  v_add_f32 v41, v41, v91
  v_fma_f32 v44, v90, v90, v44
  v_fma_f32 v45, v91, v91, v45
  v_add_f32 v42, v42, v94
  v_add_f32 v43, v43, v95
  v_fma_f32 v46, v94, v94, v46
  v_fma_f32 v47, v95, v95, v47
  v_add_f32 v122, v40, v41
  v_add_f32 v14, v44, v45
  v_add_f32 v123, v42, v43
  v_add_f32 v15, v46, v47
  v_cmp_gt_u32 vcc, 32, v1
  v_bfe_u32 v24, v1, 4, 1
  v_permlane32_swap_b32 v120, v122
  v_permlane32_swap_b32 v121, v123
  v_permlane32_swap_b32 v10, v14
  v_permlane32_swap_b32 v11, v15
  v_add_f32 v120, v120, v122
  v_add_f32 v121, v121, v123
  v_add_f32 v10, v10, v14
  v_add_f32 v11, v11, v15
  v_cndmask_b32 v25, v3, v2, vcc
  v_lshl_add_u32 v25, v24, 7, v25
  v_permlane16_swap_b32 v120, v121
  v_permlane16_swap_b32 v10, v11
  s_lshl_b32 s36, s46, 10
  v_add_u32 v25, s36, v25
  v_add_f32 v120, v120, v121
  v_add_f32 v121, v10, v11
  v_mov_b32 v122, 79872
  v_mov_b32 v123, 1
  ds_write_b64 v25, v[120:121] offset:32768
  s_mov_b64 exec, 1
  ds_add_u32 v122, v123
  s_mov_b64 exec, -1
  v_mul_f32 v24, v56, v17
  v_mul_f32 v26, v57, v17
  v_mul_f32 v28, v58, v17
  v_mul_f32 v30, v59, v17
  v_mul_f32 v32, v56, v19
  v_mul_f32 v34, v57, v19
  v_mul_f32 v36, v58, v19
  v_mul_f32 v38, v59, v19
  v_fma_f32 v96, v96, v16, v24
  v_fma_f32 v97, v97, v16, v26
  v_fma_f32 v98, v98, v16, v28
  v_fma_f32 v99, v99, v16, v30
  v_fma_f32 v100, v100, v18, v32
  v_fma_f32 v101, v101, v18, v34
  v_fma_f32 v102, v102, v18, v36
  v_fma_f32 v103, v103, v18, v38
  v_mul_f32 v24, v96, v96
  v_mul_f32 v26, v97, v97
  v_mul_f32 v28, v98, v98
  v_mul_f32 v30, v99, v99
  v_mul_f32 v32, v100, v100
  v_mul_f32 v34, v101, v101
  v_mul_f32 v36, v102, v102
  v_mul_f32 v38, v103, v103
  v_fmamk_f32 v24, v24, 0xbdd2d3e8, v12
  v_fmamk_f32 v26, v26, 0xbdd2d3e8, v12
  v_fmamk_f32 v28, v28, 0xbdd2d3e8, v12
  v_fmamk_f32 v30, v30, 0xbdd2d3e8, v12
  v_fmamk_f32 v32, v32, 0xbdd2d3e8, v12
  v_fmamk_f32 v34, v34, 0xbdd2d3e8, v12
  v_fmamk_f32 v36, v36, 0xbdd2d3e8, v12
  v_fmamk_f32 v38, v38, 0xbdd2d3e8, v12
  v_mul_f32 v24, v96, v24
  v_mul_f32 v26, v97, v26
  v_mul_f32 v28, v98, v28
  v_mul_f32 v30, v99, v30
  v_mul_f32 v32, v100, v32
  v_mul_f32 v34, v101, v34
  v_mul_f32 v36, v102, v36
  v_mul_f32 v38, v103, v38
  v_exp_f32 v25, v24
  v_exp_f32 v27, v26
  v_exp_f32 v29, v28
  v_exp_f32 v31, v30
  v_exp_f32 v33, v32
  v_exp_f32 v35, v34
  v_exp_f32 v37, v36
  v_exp_f32 v39, v38
  v_add_f32 v25, 1.0, v25
  v_add_f32 v27, 1.0, v27
  v_add_f32 v29, 1.0, v29
  v_add_f32 v31, 1.0, v31
  v_add_f32 v33, 1.0, v33
  v_add_f32 v35, 1.0, v35
  v_add_f32 v37, 1.0, v37
  v_add_f32 v39, 1.0, v39
  v_rcp_f32 v25, v25
  v_rcp_f32 v27, v27
  v_rcp_f32 v29, v29
  v_rcp_f32 v31, v31
  v_rcp_f32 v33, v33
  v_rcp_f32 v35, v35
  v_rcp_f32 v37, v37
  v_rcp_f32 v39, v39
  v_mul_f32 v96, v96, v25
  v_mul_f32 v97, v97, v27
  v_mul_f32 v98, v98, v29
  v_mul_f32 v99, v99, v31
  v_mul_f32 v100, v100, v33
  v_mul_f32 v101, v101, v35
  v_mul_f32 v102, v102, v37
  v_mul_f32 v103, v103, v39
  v_cvt_pk_bf16_f32 v96, v96, v97
  v_cvt_pk_bf16_f32 v97, v98, v99
  v_cvt_pk_bf16_f32 v98, v100, v101
  v_cvt_pk_bf16_f32 v99, v102, v103
  s_nop 0
  v_permlane16_swap_b32 v96, v98
  v_permlane16_swap_b32 v97, v99
  v_mul_f32 v24, v56, v21
  v_mul_f32 v26, v57, v21
  v_mul_f32 v28, v58, v21
  v_mul_f32 v30, v59, v21
  v_mul_f32 v32, v56, v23
  v_mul_f32 v34, v57, v23
  v_mul_f32 v36, v58, v23
  v_mul_f32 v38, v59, v23
  v_fma_f32 v104, v104, v20, v24
  v_fma_f32 v105, v105, v20, v26
  v_fma_f32 v106, v106, v20, v28
  v_fma_f32 v107, v107, v20, v30
  v_fma_f32 v108, v108, v22, v32
  v_fma_f32 v109, v109, v22, v34
  v_fma_f32 v110, v110, v22, v36
  v_fma_f32 v111, v111, v22, v38
  v_mul_f32 v24, v104, v104
  v_mul_f32 v26, v105, v105
  v_mul_f32 v28, v106, v106
  v_mul_f32 v30, v107, v107
  v_mul_f32 v32, v108, v108
  v_mul_f32 v34, v109, v109
  v_mul_f32 v36, v110, v110
  v_mul_f32 v38, v111, v111
  v_fmamk_f32 v24, v24, 0xbdd2d3e8, v12
  v_fmamk_f32 v26, v26, 0xbdd2d3e8, v12
  v_fmamk_f32 v28, v28, 0xbdd2d3e8, v12
  v_fmamk_f32 v30, v30, 0xbdd2d3e8, v12
  v_fmamk_f32 v32, v32, 0xbdd2d3e8, v12
  v_fmamk_f32 v34, v34, 0xbdd2d3e8, v12
  v_fmamk_f32 v36, v36, 0xbdd2d3e8, v12
  v_fmamk_f32 v38, v38, 0xbdd2d3e8, v12
  v_mul_f32 v24, v104, v24
  v_mul_f32 v26, v105, v26
  v_mul_f32 v28, v106, v28
  v_mul_f32 v30, v107, v30
  v_mul_f32 v32, v108, v32
  v_mul_f32 v34, v109, v34
  v_mul_f32 v36, v110, v36
  v_mul_f32 v38, v111, v38
  v_exp_f32 v25, v24
  v_exp_f32 v27, v26
  v_exp_f32 v29, v28
  v_exp_f32 v31, v30
  v_exp_f32 v33, v32
  v_exp_f32 v35, v34
  v_exp_f32 v37, v36
  v_exp_f32 v39, v38
  v_add_f32 v25, 1.0, v25
  v_add_f32 v27, 1.0, v27
  v_add_f32 v29, 1.0, v29
  v_add_f32 v31, 1.0, v31
  v_add_f32 v33, 1.0, v33
  v_add_f32 v35, 1.0, v35
  v_add_f32 v37, 1.0, v37
  v_add_f32 v39, 1.0, v39
  v_rcp_f32 v25, v25
  v_rcp_f32 v27, v27
  v_rcp_f32 v29, v29
  v_rcp_f32 v31, v31
  v_rcp_f32 v33, v33
  v_rcp_f32 v35, v35
  v_rcp_f32 v37, v37
  v_rcp_f32 v39, v39
  v_mul_f32 v104, v104, v25
  v_mul_f32 v105, v105, v27
  v_mul_f32 v106, v106, v29
  v_mul_f32 v107, v107, v31
  v_mul_f32 v108, v108, v33
  v_mul_f32 v109, v109, v35
  v_mul_f32 v110, v110, v37
  v_mul_f32 v111, v111, v39
  v_cvt_pk_bf16_f32 v104, v104, v105
  v_cvt_pk_bf16_f32 v105, v106, v107
  v_cvt_pk_bf16_f32 v106, v108, v109
  v_cvt_pk_bf16_f32 v107, v110, v111
  s_nop 0
  v_permlane16_swap_b32 v104, v106
  v_permlane16_swap_b32 v105, v107
  v_mul_f32 v24, v60, v17
  v_mul_f32 v26, v61, v17
  v_mul_f32 v28, v62, v17
  v_mul_f32 v30, v63, v17
  v_mul_f32 v32, v60, v19
  v_mul_f32 v34, v61, v19
  v_mul_f32 v36, v62, v19
  v_mul_f32 v38, v63, v19
  v_fma_f32 v112, v112, v16, v24
  v_fma_f32 v113, v113, v16, v26
  v_fma_f32 v114, v114, v16, v28
  v_fma_f32 v115, v115, v16, v30
  v_fma_f32 v116, v116, v18, v32
  v_fma_f32 v117, v117, v18, v34
  v_fma_f32 v118, v118, v18, v36
  v_fma_f32 v119, v119, v18, v38
  v_mul_f32 v24, v112, v112
  v_mul_f32 v26, v113, v113
  v_mul_f32 v28, v114, v114
  v_mul_f32 v30, v115, v115
  v_mul_f32 v32, v116, v116
  v_mul_f32 v34, v117, v117
  v_mul_f32 v36, v118, v118
  v_mul_f32 v38, v119, v119
  v_fmamk_f32 v24, v24, 0xbdd2d3e8, v12
  v_fmamk_f32 v26, v26, 0xbdd2d3e8, v12
  v_fmamk_f32 v28, v28, 0xbdd2d3e8, v12
  v_fmamk_f32 v30, v30, 0xbdd2d3e8, v12
  v_fmamk_f32 v32, v32, 0xbdd2d3e8, v12
  v_fmamk_f32 v34, v34, 0xbdd2d3e8, v12
  v_fmamk_f32 v36, v36, 0xbdd2d3e8, v12
  v_fmamk_f32 v38, v38, 0xbdd2d3e8, v12
  v_mul_f32 v24, v112, v24
  v_mul_f32 v26, v113, v26
  v_mul_f32 v28, v114, v28
  v_mul_f32 v30, v115, v30
  v_mul_f32 v32, v116, v32
  v_mul_f32 v34, v117, v34
  v_mul_f32 v36, v118, v36
  v_mul_f32 v38, v119, v38
  v_exp_f32 v25, v24
  v_exp_f32 v27, v26
  v_exp_f32 v29, v28
  v_exp_f32 v31, v30
  v_exp_f32 v33, v32
  v_exp_f32 v35, v34
  v_exp_f32 v37, v36
  v_exp_f32 v39, v38
  v_add_f32 v25, 1.0, v25
  v_add_f32 v27, 1.0, v27
  v_add_f32 v29, 1.0, v29
  v_add_f32 v31, 1.0, v31
  v_add_f32 v33, 1.0, v33
  v_add_f32 v35, 1.0, v35
  v_add_f32 v37, 1.0, v37
  v_add_f32 v39, 1.0, v39
  v_rcp_f32 v25, v25
  v_rcp_f32 v27, v27
  v_rcp_f32 v29, v29
  v_rcp_f32 v31, v31
  v_rcp_f32 v33, v33
  v_rcp_f32 v35, v35
  v_rcp_f32 v37, v37
  v_rcp_f32 v39, v39
  v_mul_f32 v112, v112, v25
  v_mul_f32 v113, v113, v27
  v_mul_f32 v114, v114, v29
  v_mul_f32 v115, v115, v31
  v_mul_f32 v116, v116, v33
  v_mul_f32 v117, v117, v35
  v_mul_f32 v118, v118, v37
  v_mul_f32 v119, v119, v39
  v_cvt_pk_bf16_f32 v112, v112, v113
  v_cvt_pk_bf16_f32 v113, v114, v115
  v_cvt_pk_bf16_f32 v114, v116, v117
  v_cvt_pk_bf16_f32 v115, v118, v119
  s_nop 0
  v_permlane16_swap_b32 v112, v114
  v_permlane16_swap_b32 v113, v115
  v_lshlrev_b32 v8, 2, v2
  v_lshlrev_b32 v9, 2, v3
  v_add_u32 v8, 36864, v8
  v_add_u32 v9, 36864, v9
  v_mov_b32 v120, 0x3a924925
  s_barrier
  ds_read_b128 v[24:27], v8 offset:0
  ds_read_b128 v[28:31], v8 offset:16
  ds_read_b128 v[32:35], v8 offset:512
  ds_read_b128 v[36:39], v8 offset:528
  s_waitcnt lgkmcnt(0)
  v_add_f32 v24, v24, v26
  v_add_f32 v25, v25, v27
  v_add_f32 v28, v28, v30
  v_add_f32 v29, v29, v31
  v_add_f32 v32, v32, v34
  v_add_f32 v33, v33, v35
  v_add_f32 v36, v36, v38
  v_add_f32 v37, v37, v39
  v_add_f32 v24, v24, v28
  v_add_f32 v25, v25, v29
  v_add_f32 v32, v32, v36
  v_add_f32 v33, v33, v37
  v_mul_f32 v24, v120, v24
  v_mul_f32 v32, v120, v32
  v_mul_f32 v26, v24, v24
  v_mul_f32 v34, v32, v32
  v_fma_f32 v26, v25, v120, -v26
  v_fma_f32 v34, v33, v120, -v34
  v_max_f32 v26, 0, v26
  v_max_f32 v34, 0, v34
  v_add_f32 v26, 0x3727c5ac, v26
  v_add_f32 v34, 0x3727c5ac, v34
  v_rsq_f32 v16, v26
  v_rsq_f32 v18, v34
  v_mul_f32 v17, -v24, v16
  v_mul_f32 v19, -v32, v18
  v_fma_f32 v64, v64, v16, v17
  v_fma_f32 v65, v65, v16, v17
  v_fma_f32 v66, v66, v16, v17
  v_fma_f32 v67, v67, v16, v17
  v_fma_f32 v68, v68, v18, v19
  v_fma_f32 v69, v69, v18, v19
  v_fma_f32 v70, v70, v18, v19
  v_fma_f32 v71, v71, v18, v19
  v_cvt_pk_bf16_f32 v64, v64, v65
  v_cvt_pk_bf16_f32 v65, v66, v67
  v_cvt_pk_bf16_f32 v66, v68, v69
  v_cvt_pk_bf16_f32 v67, v70, v71
  s_nop 0
  v_permlane16_swap_b32 v64, v66
  v_permlane16_swap_b32 v65, v67
  buffer_store_dwordx4 v[64:67], v6, s[16:19], s52 offen offset:0 sc1
  v_fma_f32 v80, v80, v16, v17
  v_fma_f32 v81, v81, v16, v17
  v_fma_f32 v82, v82, v16, v17
  v_fma_f32 v83, v83, v16, v17
  v_fma_f32 v84, v84, v18, v19
  v_fma_f32 v85, v85, v18, v19
  v_fma_f32 v86, v86, v18, v19
  v_fma_f32 v87, v87, v18, v19
  v_cvt_pk_bf16_f32 v80, v80, v81
  v_cvt_pk_bf16_f32 v81, v82, v83
  v_cvt_pk_bf16_f32 v82, v84, v85
  v_cvt_pk_bf16_f32 v83, v86, v87
  s_nop 0
  v_permlane16_swap_b32 v80, v82
  v_permlane16_swap_b32 v81, v83
  buffer_store_dwordx4 v[80:83], v6, s[16:19], s52 offen offset:1024 sc1
  ds_read_b128 v[24:27], v9 offset:0
  ds_read_b128 v[28:31], v9 offset:16
  ds_read_b128 v[32:35], v9 offset:512
  ds_read_b128 v[36:39], v9 offset:528
  s_waitcnt lgkmcnt(0)
  v_add_f32 v24, v24, v26
  v_add_f32 v25, v25, v27
  v_add_f32 v28, v28, v30
  v_add_f32 v29, v29, v31
  v_add_f32 v32, v32, v34
  v_add_f32 v33, v33, v35
  v_add_f32 v36, v36, v38
  v_add_f32 v37, v37, v39
  v_add_f32 v24, v24, v28
  v_add_f32 v25, v25, v29
  v_add_f32 v32, v32, v36
  v_add_f32 v33, v33, v37
  v_mul_f32 v24, v120, v24
  v_mul_f32 v32, v120, v32
  v_mul_f32 v26, v24, v24
  v_mul_f32 v34, v32, v32
  v_fma_f32 v26, v25, v120, -v26
  v_fma_f32 v34, v33, v120, -v34
  v_max_f32 v26, 0, v26
  v_max_f32 v34, 0, v34
  v_add_f32 v26, 0x3727c5ac, v26
  v_add_f32 v34, 0x3727c5ac, v34
  v_rsq_f32 v20, v26
  v_rsq_f32 v22, v34
  v_mul_f32 v21, -v24, v20
  v_mul_f32 v23, -v32, v22
  v_fma_f32 v72, v72, v20, v21
  v_fma_f32 v73, v73, v20, v21
  v_fma_f32 v74, v74, v20, v21
  v_fma_f32 v75, v75, v20, v21
  v_fma_f32 v76, v76, v22, v23
  v_fma_f32 v77, v77, v22, v23
  v_fma_f32 v78, v78, v22, v23
  v_fma_f32 v79, v79, v22, v23
  v_cvt_pk_bf16_f32 v72, v72, v73
  v_cvt_pk_bf16_f32 v73, v74, v75
  v_cvt_pk_bf16_f32 v74, v76, v77
  v_cvt_pk_bf16_f32 v75, v78, v79
  s_nop 0
  v_permlane16_swap_b32 v72, v74
  v_permlane16_swap_b32 v73, v75
  buffer_store_dwordx4 v[72:75], v6, s[16:19], s53 offen offset:0 sc1
  v_fma_f32 v88, v88, v20, v21
  v_fma_f32 v89, v89, v20, v21
  v_fma_f32 v90, v90, v20, v21
  v_fma_f32 v91, v91, v20, v21
  v_fma_f32 v92, v92, v22, v23
  v_fma_f32 v93, v93, v22, v23
  v_fma_f32 v94, v94, v22, v23
  v_fma_f32 v95, v95, v22, v23
  v_cvt_pk_bf16_f32 v88, v88, v89
  v_cvt_pk_bf16_f32 v89, v90, v91
  v_cvt_pk_bf16_f32 v90, v92, v93
  v_cvt_pk_bf16_f32 v91, v94, v95
  s_nop 0
  v_permlane16_swap_b32 v88, v90
  v_permlane16_swap_b32 v89, v91
  buffer_store_dwordx4 v[88:91], v6, s[16:19], s53 offen offset:1024 sc1
  s_waitcnt vmcnt(0)
  s_barrier
  s_barrier
  buffer_store_dwordx4 v[96:99], v5, s[16:19], s54 offen offset:0 sc1
  buffer_store_dwordx4 v[104:107], v5, s[16:19], s55 offen offset:0 sc1
  buffer_store_dwordx4 v[112:115], v4, s[16:19], s54 offen offset:1024 sc1
  s_branch L_Z_cend
L_Z_e1:
  v_mul_f32 v24, v56, v17
  v_mul_f32 v26, v57, v17
  v_mul_f32 v28, v58, v17
  v_mul_f32 v30, v59, v17
  v_mul_f32 v32, v56, v19
  v_mul_f32 v34, v57, v19
  v_mul_f32 v36, v58, v19
  v_mul_f32 v38, v59, v19
  v_fma_f32 v96, v96, v16, v24
  v_fma_f32 v97, v97, v16, v26
  v_fma_f32 v98, v98, v16, v28
  v_fma_f32 v99, v99, v16, v30
  v_fma_f32 v100, v100, v18, v32
  v_fma_f32 v101, v101, v18, v34
  v_fma_f32 v102, v102, v18, v36
  v_fma_f32 v103, v103, v18, v38
  v_mul_f32 v24, v96, v96
  v_mul_f32 v26, v97, v97
  v_mul_f32 v28, v98, v98
  v_mul_f32 v30, v99, v99
  v_mul_f32 v32, v100, v100
  v_mul_f32 v34, v101, v101
  v_mul_f32 v36, v102, v102
  v_mul_f32 v38, v103, v103
  v_fmamk_f32 v24, v24, 0xbdd2d3e8, v12
  v_fmamk_f32 v26, v26, 0xbdd2d3e8, v12
  v_fmamk_f32 v28, v28, 0xbdd2d3e8, v12
  v_fmamk_f32 v30, v30, 0xbdd2d3e8, v12
  v_fmamk_f32 v32, v32, 0xbdd2d3e8, v12
  v_fmamk_f32 v34, v34, 0xbdd2d3e8, v12
  v_fmamk_f32 v36, v36, 0xbdd2d3e8, v12
  v_fmamk_f32 v38, v38, 0xbdd2d3e8, v12
  v_mul_f32 v24, v96, v24
  v_mul_f32 v26, v97, v26
  v_mul_f32 v28, v98, v28
  v_mul_f32 v30, v99, v30
  v_mul_f32 v32, v100, v32
  v_mul_f32 v34, v101, v34
  v_mul_f32 v36, v102, v36
  v_mul_f32 v38, v103, v38
  v_exp_f32 v25, v24
  v_exp_f32 v27, v26
  v_exp_f32 v29, v28
  v_exp_f32 v31, v30
  v_exp_f32 v33, v32
  v_exp_f32 v35, v34
  v_exp_f32 v37, v36
  v_exp_f32 v39, v38
  v_add_f32 v25, 1.0, v25
  v_add_f32 v27, 1.0, v27
  v_add_f32 v29, 1.0, v29
  v_add_f32 v31, 1.0, v31
  v_add_f32 v33, 1.0, v33
  v_add_f32 v35, 1.0, v35
  v_add_f32 v37, 1.0, v37
  v_add_f32 v39, 1.0, v39
  v_rcp_f32 v25, v25
  v_rcp_f32 v27, v27
  v_rcp_f32 v29, v29
  v_rcp_f32 v31, v31
  v_rcp_f32 v33, v33
  v_rcp_f32 v35, v35
  v_rcp_f32 v37, v37
  v_rcp_f32 v39, v39
  v_mul_f32 v96, v96, v25
  v_mul_f32 v97, v97, v27
  v_mul_f32 v98, v98, v29
  v_mul_f32 v99, v99, v31
  v_mul_f32 v100, v100, v33
  v_mul_f32 v101, v101, v35
  v_mul_f32 v102, v102, v37
  v_mul_f32 v103, v103, v39
  v_add_f32 v40, v96, v98
  v_add_f32 v41, v97, v99
  v_mul_f32 v44, v96, v96
  v_mul_f32 v45, v97, v97
  v_add_f32 v42, v100, v102
  v_add_f32 v43, v101, v103
  v_mul_f32 v46, v100, v100
  v_mul_f32 v47, v101, v101
  v_fma_f32 v44, v98, v98, v44
  v_fma_f32 v45, v99, v99, v45
  v_fma_f32 v46, v102, v102, v46
  v_fma_f32 v47, v103, v103, v47
  v_mul_f32 v24, v60, v17
  v_mul_f32 v26, v61, v17
  v_mul_f32 v28, v62, v17
  v_mul_f32 v30, v63, v17
  v_mul_f32 v32, v60, v19
  v_mul_f32 v34, v61, v19
  v_mul_f32 v36, v62, v19
  v_mul_f32 v38, v63, v19
  v_fma_f32 v112, v112, v16, v24
  v_fma_f32 v113, v113, v16, v26
  v_fma_f32 v114, v114, v16, v28
  v_fma_f32 v115, v115, v16, v30
  v_fma_f32 v116, v116, v18, v32
  v_fma_f32 v117, v117, v18, v34
  v_fma_f32 v118, v118, v18, v36
  v_fma_f32 v119, v119, v18, v38
  v_mul_f32 v24, v112, v112
  v_mul_f32 v26, v113, v113
  v_mul_f32 v28, v114, v114
  v_mul_f32 v30, v115, v115
  v_mul_f32 v32, v116, v116
  v_mul_f32 v34, v117, v117
  v_mul_f32 v36, v118, v118
  v_mul_f32 v38, v119, v119
  v_fmamk_f32 v24, v24, 0xbdd2d3e8, v12
  v_fmamk_f32 v26, v26, 0xbdd2d3e8, v12
  v_fmamk_f32 v28, v28, 0xbdd2d3e8, v12
  v_fmamk_f32 v30, v30, 0xbdd2d3e8, v12
  v_fmamk_f32 v32, v32, 0xbdd2d3e8, v12
  v_fmamk_f32 v34, v34, 0xbdd2d3e8, v12
  v_fmamk_f32 v36, v36, 0xbdd2d3e8, v12
  v_fmamk_f32 v38, v38, 0xbdd2d3e8, v12
  v_mul_f32 v24, v112, v24
  v_mul_f32 v26, v113, v26
  v_mul_f32 v28, v114, v28
  v_mul_f32 v30, v115, v30
  v_mul_f32 v32, v116, v32
  v_mul_f32 v34, v117, v34
  v_mul_f32 v36, v118, v36
  v_mul_f32 v38, v119, v38
  v_exp_f32 v25, v24
  v_exp_f32 v27, v26
  v_exp_f32 v29, v28
  v_exp_f32 v31, v30
  v_exp_f32 v33, v32
  v_exp_f32 v35, v34
  v_exp_f32 v37, v36
  v_exp_f32 v39, v38
  v_add_f32 v25, 1.0, v25
  v_add_f32 v27, 1.0, v27
  v_add_f32 v29, 1.0, v29
  v_add_f32 v31, 1.0, v31
  v_add_f32 v33, 1.0, v33
  v_add_f32 v35, 1.0, v35
  v_add_f32 v37, 1.0, v37
  v_add_f32 v39, 1.0, v39
  v_rcp_f32 v25, v25
  v_rcp_f32 v27, v27
  v_rcp_f32 v29, v29
  v_rcp_f32 v31, v31
  v_rcp_f32 v33, v33
  v_rcp_f32 v35, v35
  v_rcp_f32 v37, v37
  v_rcp_f32 v39, v39
  v_mul_f32 v112, v112, v25
  v_mul_f32 v113, v113, v27
  v_mul_f32 v114, v114, v29
  v_mul_f32 v115, v115, v31
  v_mul_f32 v116, v116, v33
  v_mul_f32 v117, v117, v35
  v_mul_f32 v118, v118, v37
  v_mul_f32 v119, v119, v39
  v_add_f32 v40, v40, v112
  v_add_f32 v41, v41, v113
  v_fma_f32 v44, v112, v112, v44
  v_fma_f32 v45, v113, v113, v45
  v_add_f32 v42, v42, v116
  v_add_f32 v43, v43, v117
  v_fma_f32 v46, v116, v116, v46
  v_fma_f32 v47, v117, v117, v47
  v_add_f32 v40, v40, v114
  v_add_f32 v41, v41, v115
  v_fma_f32 v44, v114, v114, v44
  v_fma_f32 v45, v115, v115, v45
  v_add_f32 v42, v42, v118
  v_add_f32 v43, v43, v119
  v_fma_f32 v46, v118, v118, v46
  v_fma_f32 v47, v119, v119, v47
  v_add_f32 v120, v40, v41
  v_add_f32 v10, v44, v45
  v_add_f32 v121, v42, v43
  v_add_f32 v11, v46, v47
  v_mul_f32 v24, v56, v21
  v_mul_f32 v26, v57, v21
  v_mul_f32 v28, v58, v21
  v_mul_f32 v30, v59, v21
  v_mul_f32 v32, v56, v23
  v_mul_f32 v34, v57, v23
  v_mul_f32 v36, v58, v23
  v_mul_f32 v38, v59, v23
  v_fma_f32 v104, v104, v20, v24
  v_fma_f32 v105, v105, v20, v26
  v_fma_f32 v106, v106, v20, v28
  v_fma_f32 v107, v107, v20, v30
  v_fma_f32 v108, v108, v22, v32
  v_fma_f32 v109, v109, v22, v34
  v_fma_f32 v110, v110, v22, v36
  v_fma_f32 v111, v111, v22, v38
  v_mul_f32 v24, v104, v104
  v_mul_f32 v26, v105, v105
  v_mul_f32 v28, v106, v106
  v_mul_f32 v30, v107, v107
  v_mul_f32 v32, v108, v108
  v_mul_f32 v34, v109, v109
  v_mul_f32 v36, v110, v110
  v_mul_f32 v38, v111, v111
  v_fmamk_f32 v24, v24, 0xbdd2d3e8, v12
  v_fmamk_f32 v26, v26, 0xbdd2d3e8, v12
  v_fmamk_f32 v28, v28, 0xbdd2d3e8, v12
  v_fmamk_f32 v30, v30, 0xbdd2d3e8, v12
  v_fmamk_f32 v32, v32, 0xbdd2d3e8, v12
  v_fmamk_f32 v34, v34, 0xbdd2d3e8, v12
  v_fmamk_f32 v36, v36, 0xbdd2d3e8, v12
  v_fmamk_f32 v38, v38, 0xbdd2d3e8, v12
  v_mul_f32 v24, v104, v24
  v_mul_f32 v26, v105, v26
  v_mul_f32 v28, v106, v28
  v_mul_f32 v30, v107, v30
  v_mul_f32 v32, v108, v32
  v_mul_f32 v34, v109, v34
  v_mul_f32 v36, v110, v36
  v_mul_f32 v38, v111, v38
  v_exp_f32 v25, v24
  v_exp_f32 v27, v26
  v_exp_f32 v29, v28
  v_exp_f32 v31, v30
  v_exp_f32 v33, v32
  v_exp_f32 v35, v34
  v_exp_f32 v37, v36
  v_exp_f32 v39, v38
  v_add_f32 v25, 1.0, v25
  v_add_f32 v27, 1.0, v27
  v_add_f32 v29, 1.0, v29
  v_add_f32 v31, 1.0, v31
  v_add_f32 v33, 1.0, v33
  v_add_f32 v35, 1.0, v35
  v_add_f32 v37, 1.0, v37
  v_add_f32 v39, 1.0, v39
  v_rcp_f32 v25, v25
  v_rcp_f32 v27, v27
  v_rcp_f32 v29, v29
  v_rcp_f32 v31, v31
  v_rcp_f32 v33, v33
  v_rcp_f32 v35, v35
  v_rcp_f32 v37, v37
  v_rcp_f32 v39, v39
  v_mul_f32 v104, v104, v25
  v_mul_f32 v105, v105, v27
  v_mul_f32 v106, v106, v29
  v_mul_f32 v107, v107, v31
  v_mul_f32 v108, v108, v33
  v_mul_f32 v109, v109, v35
  v_mul_f32 v110, v110, v37
  v_mul_f32 v111, v111, v39
  v_add_f32 v40, v104, v106
  v_add_f32 v41, v105, v107
  v_mul_f32 v44, v104, v104
  v_mul_f32 v45, v105, v105
  v_add_f32 v42, v108, v110
  v_add_f32 v43, v109, v111
  v_mul_f32 v46, v108, v108
  v_mul_f32 v47, v109, v109
  v_fma_f32 v44, v106, v106, v44
  v_fma_f32 v45, v107, v107, v45
  v_fma_f32 v46, v110, v110, v46
  v_fma_f32 v47, v111, v111, v47
  v_add_f32 v122, v40, v41
  v_add_f32 v14, v44, v45
  v_add_f32 v123, v42, v43
  v_add_f32 v15, v46, v47
  v_cmp_gt_u32 vcc, 32, v1
  v_bfe_u32 v24, v1, 4, 1
  v_permlane32_swap_b32 v120, v122
  v_permlane32_swap_b32 v121, v123
  v_permlane32_swap_b32 v10, v14
  v_permlane32_swap_b32 v11, v15
  v_add_f32 v120, v120, v122
  v_add_f32 v121, v121, v123
  v_add_f32 v10, v10, v14
  v_add_f32 v11, v11, v15
  v_cndmask_b32 v25, v3, v2, vcc
  v_lshl_add_u32 v25, v24, 7, v25
  v_permlane16_swap_b32 v120, v121
  v_permlane16_swap_b32 v10, v11
  s_lshl_b32 s36, s46, 10
  v_add_u32 v25, s36, v25
  v_add_f32 v120, v120, v121
  v_add_f32 v121, v10, v11
  v_mov_b32 v122, 79872
  v_mov_b32 v123, 1
  ds_write_b64 v25, v[120:121] offset:32768
  s_mov_b64 exec, 1
  ds_add_u32 v122, v123
  s_mov_b64 exec, -1
  v_mul_f32 v24, v48, v17
  v_mul_f32 v26, v49, v17
  v_mul_f32 v28, v50, v17
  v_mul_f32 v30, v51, v17
  v_mul_f32 v32, v48, v19
  v_mul_f32 v34, v49, v19
  v_mul_f32 v36, v50, v19
  v_mul_f32 v38, v51, v19
  v_fma_f32 v64, v64, v16, v24
  v_fma_f32 v65, v65, v16, v26
  v_fma_f32 v66, v66, v16, v28
  v_fma_f32 v67, v67, v16, v30
  v_fma_f32 v68, v68, v18, v32
  v_fma_f32 v69, v69, v18, v34
  v_fma_f32 v70, v70, v18, v36
  v_fma_f32 v71, v71, v18, v38
  v_mul_f32 v24, v64, v64
  v_mul_f32 v26, v65, v65
  v_mul_f32 v28, v66, v66
  v_mul_f32 v30, v67, v67
  v_mul_f32 v32, v68, v68
  v_mul_f32 v34, v69, v69
  v_mul_f32 v36, v70, v70
  v_mul_f32 v38, v71, v71
  v_fmamk_f32 v24, v24, 0xbdd2d3e8, v12
  v_fmamk_f32 v26, v26, 0xbdd2d3e8, v12
  v_fmamk_f32 v28, v28, 0xbdd2d3e8, v12
  v_fmamk_f32 v30, v30, 0xbdd2d3e8, v12
  v_fmamk_f32 v32, v32, 0xbdd2d3e8, v12
  v_fmamk_f32 v34, v34, 0xbdd2d3e8, v12
  v_fmamk_f32 v36, v36, 0xbdd2d3e8, v12
  v_fmamk_f32 v38, v38, 0xbdd2d3e8, v12
  v_mul_f32 v24, v64, v24
  v_mul_f32 v26, v65, v26
  v_mul_f32 v28, v66, v28
  v_mul_f32 v30, v67, v30
  v_mul_f32 v32, v68, v32
  v_mul_f32 v34, v69, v34
  v_mul_f32 v36, v70, v36
  v_mul_f32 v38, v71, v38
  v_exp_f32 v25, v24
  v_exp_f32 v27, v26
  v_exp_f32 v29, v28
  v_exp_f32 v31, v30
  v_exp_f32 v33, v32
  v_exp_f32 v35, v34
  v_exp_f32 v37, v36
  v_exp_f32 v39, v38
  v_add_f32 v25, 1.0, v25
  v_add_f32 v27, 1.0, v27
  v_add_f32 v29, 1.0, v29
  v_add_f32 v31, 1.0, v31
  v_add_f32 v33, 1.0, v33
  v_add_f32 v35, 1.0, v35
  v_add_f32 v37, 1.0, v37
  v_add_f32 v39, 1.0, v39
  v_rcp_f32 v25, v25
  v_rcp_f32 v27, v27
  v_rcp_f32 v29, v29
  v_rcp_f32 v31, v31
  v_rcp_f32 v33, v33
  v_rcp_f32 v35, v35
  v_rcp_f32 v37, v37
  v_rcp_f32 v39, v39
  v_mul_f32 v64, v64, v25
  v_mul_f32 v65, v65, v27
  v_mul_f32 v66, v66, v29
  v_mul_f32 v67, v67, v31
  v_mul_f32 v68, v68, v33
  v_mul_f32 v69, v69, v35
  v_mul_f32 v70, v70, v37
  v_mul_f32 v71, v71, v39
  v_cvt_pk_bf16_f32 v64, v64, v65
  v_cvt_pk_bf16_f32 v65, v66, v67
  v_cvt_pk_bf16_f32 v66, v68, v69
  v_cvt_pk_bf16_f32 v67, v70, v71
  s_nop 0
  v_permlane16_swap_b32 v64, v66
  v_permlane16_swap_b32 v65, v67
  v_mul_f32 v24, v48, v21
  v_mul_f32 v26, v49, v21
  v_mul_f32 v28, v50, v21
  v_mul_f32 v30, v51, v21
  v_mul_f32 v32, v48, v23
  v_mul_f32 v34, v49, v23
  v_mul_f32 v36, v50, v23
  v_mul_f32 v38, v51, v23
  v_fma_f32 v72, v72, v20, v24
  v_fma_f32 v73, v73, v20, v26
  v_fma_f32 v74, v74, v20, v28
  v_fma_f32 v75, v75, v20, v30
  v_fma_f32 v76, v76, v22, v32
  v_fma_f32 v77, v77, v22, v34
  v_fma_f32 v78, v78, v22, v36
  v_fma_f32 v79, v79, v22, v38
  v_mul_f32 v24, v72, v72
  v_mul_f32 v26, v73, v73
  v_mul_f32 v28, v74, v74
  v_mul_f32 v30, v75, v75
  v_mul_f32 v32, v76, v76
  v_mul_f32 v34, v77, v77
  v_mul_f32 v36, v78, v78
  v_mul_f32 v38, v79, v79
  v_fmamk_f32 v24, v24, 0xbdd2d3e8, v12
  v_fmamk_f32 v26, v26, 0xbdd2d3e8, v12
  v_fmamk_f32 v28, v28, 0xbdd2d3e8, v12
  v_fmamk_f32 v30, v30, 0xbdd2d3e8, v12
  v_fmamk_f32 v32, v32, 0xbdd2d3e8, v12
  v_fmamk_f32 v34, v34, 0xbdd2d3e8, v12
  v_fmamk_f32 v36, v36, 0xbdd2d3e8, v12
  v_fmamk_f32 v38, v38, 0xbdd2d3e8, v12
  v_mul_f32 v24, v72, v24
  v_mul_f32 v26, v73, v26
  v_mul_f32 v28, v74, v28
  v_mul_f32 v30, v75, v30
  v_mul_f32 v32, v76, v32
  v_mul_f32 v34, v77, v34
  v_mul_f32 v36, v78, v36
  v_mul_f32 v38, v79, v38
  v_exp_f32 v25, v24
  v_exp_f32 v27, v26
  v_exp_f32 v29, v28
  v_exp_f32 v31, v30
  v_exp_f32 v33, v32
  v_exp_f32 v35, v34
  v_exp_f32 v37, v36
  v_exp_f32 v39, v38
  v_add_f32 v25, 1.0, v25
  v_add_f32 v27, 1.0, v27
  v_add_f32 v29, 1.0, v29
  v_add_f32 v31, 1.0, v31
  v_add_f32 v33, 1.0, v33
  v_add_f32 v35, 1.0, v35
  v_add_f32 v37, 1.0, v37
  v_add_f32 v39, 1.0, v39
  v_rcp_f32 v25, v25
  v_rcp_f32 v27, v27
  v_rcp_f32 v29, v29
  v_rcp_f32 v31, v31
  v_rcp_f32 v33, v33
  v_rcp_f32 v35, v35
  v_rcp_f32 v37, v37
  v_rcp_f32 v39, v39
  v_mul_f32 v72, v72, v25
  v_mul_f32 v73, v73, v27
  v_mul_f32 v74, v74, v29
  v_mul_f32 v75, v75, v31
  v_mul_f32 v76, v76, v33
  v_mul_f32 v77, v77, v35
  v_mul_f32 v78, v78, v37
  v_mul_f32 v79, v79, v39
  v_cvt_pk_bf16_f32 v72, v72, v73
  v_cvt_pk_bf16_f32 v73, v74, v75
  v_cvt_pk_bf16_f32 v74, v76, v77
  v_cvt_pk_bf16_f32 v75, v78, v79
  s_nop 0
  v_permlane16_swap_b32 v72, v74
  v_permlane16_swap_b32 v73, v75
  v_mul_f32 v24, v52, v17
  v_mul_f32 v26, v53, v17
  v_mul_f32 v28, v54, v17
  v_mul_f32 v30, v55, v17
  v_mul_f32 v32, v52, v19
  v_mul_f32 v34, v53, v19
  v_mul_f32 v36, v54, v19
  v_mul_f32 v38, v55, v19
  v_fma_f32 v80, v80, v16, v24
  v_fma_f32 v81, v81, v16, v26
  v_fma_f32 v82, v82, v16, v28
  v_fma_f32 v83, v83, v16, v30
  v_fma_f32 v84, v84, v18, v32
  v_fma_f32 v85, v85, v18, v34
  v_fma_f32 v86, v86, v18, v36
  v_fma_f32 v87, v87, v18, v38
  v_mul_f32 v24, v80, v80
  v_mul_f32 v26, v81, v81
  v_mul_f32 v28, v82, v82
  v_mul_f32 v30, v83, v83
  v_mul_f32 v32, v84, v84
  v_mul_f32 v34, v85, v85
  v_mul_f32 v36, v86, v86
  v_mul_f32 v38, v87, v87
  v_fmamk_f32 v24, v24, 0xbdd2d3e8, v12
  v_fmamk_f32 v26, v26, 0xbdd2d3e8, v12
  v_fmamk_f32 v28, v28, 0xbdd2d3e8, v12
  v_fmamk_f32 v30, v30, 0xbdd2d3e8, v12
  v_fmamk_f32 v32, v32, 0xbdd2d3e8, v12
  v_fmamk_f32 v34, v34, 0xbdd2d3e8, v12
  v_fmamk_f32 v36, v36, 0xbdd2d3e8, v12
  v_fmamk_f32 v38, v38, 0xbdd2d3e8, v12
  v_mul_f32 v24, v80, v24
  v_mul_f32 v26, v81, v26
  v_mul_f32 v28, v82, v28
  v_mul_f32 v30, v83, v30
  v_mul_f32 v32, v84, v32
  v_mul_f32 v34, v85, v34
  v_mul_f32 v36, v86, v36
  v_mul_f32 v38, v87, v38
  v_exp_f32 v25, v24
  v_exp_f32 v27, v26
  v_exp_f32 v29, v28
  v_exp_f32 v31, v30
  v_exp_f32 v33, v32
  v_exp_f32 v35, v34
  v_exp_f32 v37, v36
  v_exp_f32 v39, v38
  v_add_f32 v25, 1.0, v25
  v_add_f32 v27, 1.0, v27
  v_add_f32 v29, 1.0, v29
  v_add_f32 v31, 1.0, v31
  v_add_f32 v33, 1.0, v33
  v_add_f32 v35, 1.0, v35
  v_add_f32 v37, 1.0, v37
  v_add_f32 v39, 1.0, v39
  v_rcp_f32 v25, v25
  v_rcp_f32 v27, v27
  v_rcp_f32 v29, v29
  v_rcp_f32 v31, v31
  v_rcp_f32 v33, v33
  v_rcp_f32 v35, v35
  v_rcp_f32 v37, v37
  v_rcp_f32 v39, v39
  v_mul_f32 v80, v80, v25
  v_mul_f32 v81, v81, v27
  v_mul_f32 v82, v82, v29
  v_mul_f32 v83, v83, v31
  v_mul_f32 v84, v84, v33
  v_mul_f32 v85, v85, v35
  v_mul_f32 v86, v86, v37
  v_mul_f32 v87, v87, v39
  v_cvt_pk_bf16_f32 v80, v80, v81
  v_cvt_pk_bf16_f32 v81, v82, v83
  v_cvt_pk_bf16_f32 v82, v84, v85
  v_cvt_pk_bf16_f32 v83, v86, v87
  s_nop 0
  v_permlane16_swap_b32 v80, v82
  v_permlane16_swap_b32 v81, v83
  v_mul_f32 v24, v52, v21
  v_mul_f32 v26, v53, v21
  v_mul_f32 v28, v54, v21
  v_mul_f32 v30, v55, v21
  v_mul_f32 v32, v52, v23
  v_mul_f32 v34, v53, v23
  v_mul_f32 v36, v54, v23
  v_mul_f32 v38, v55, v23
  v_fma_f32 v88, v88, v20, v24
  v_fma_f32 v89, v89, v20, v26
  v_fma_f32 v90, v90, v20, v28
  v_fma_f32 v91, v91, v20, v30
  v_fma_f32 v92, v92, v22, v32
  v_fma_f32 v93, v93, v22, v34
  v_fma_f32 v94, v94, v22, v36
  v_fma_f32 v95, v95, v22, v38
  v_mul_f32 v24, v88, v88
  v_mul_f32 v26, v89, v89
  v_mul_f32 v28, v90, v90
  v_mul_f32 v30, v91, v91
  v_mul_f32 v32, v92, v92
  v_mul_f32 v34, v93, v93
  v_mul_f32 v36, v94, v94
  v_mul_f32 v38, v95, v95
  v_fmamk_f32 v24, v24, 0xbdd2d3e8, v12
  v_fmamk_f32 v26, v26, 0xbdd2d3e8, v12
  v_fmamk_f32 v28, v28, 0xbdd2d3e8, v12
  v_fmamk_f32 v30, v30, 0xbdd2d3e8, v12
  v_fmamk_f32 v32, v32, 0xbdd2d3e8, v12
  v_fmamk_f32 v34, v34, 0xbdd2d3e8, v12
  v_fmamk_f32 v36, v36, 0xbdd2d3e8, v12
  v_fmamk_f32 v38, v38, 0xbdd2d3e8, v12
  v_mul_f32 v24, v88, v24
  v_mul_f32 v26, v89, v26
  v_mul_f32 v28, v90, v28
  v_mul_f32 v30, v91, v30
  v_mul_f32 v32, v92, v32
  v_mul_f32 v34, v93, v34
  v_mul_f32 v36, v94, v36
  v_mul_f32 v38, v95, v38
  v_exp_f32 v25, v24
  v_exp_f32 v27, v26
  v_exp_f32 v29, v28
  v_exp_f32 v31, v30
  v_exp_f32 v33, v32
  v_exp_f32 v35, v34
  v_exp_f32 v37, v36
  v_exp_f32 v39, v38
  v_add_f32 v25, 1.0, v25
  v_add_f32 v27, 1.0, v27
  v_add_f32 v29, 1.0, v29
  v_add_f32 v31, 1.0, v31
  v_add_f32 v33, 1.0, v33
  v_add_f32 v35, 1.0, v35
  v_add_f32 v37, 1.0, v37
  v_add_f32 v39, 1.0, v39
  v_rcp_f32 v25, v25
  v_rcp_f32 v27, v27
  v_rcp_f32 v29, v29
  v_rcp_f32 v31, v31
  v_rcp_f32 v33, v33
  v_rcp_f32 v35, v35
  v_rcp_f32 v37, v37
  v_rcp_f32 v39, v39
  v_mul_f32 v88, v88, v25
  v_mul_f32 v89, v89, v27
  v_mul_f32 v90, v90, v29
  v_mul_f32 v91, v91, v31
  v_mul_f32 v92, v92, v33
  v_mul_f32 v93, v93, v35
  v_mul_f32 v94, v94, v37
  v_mul_f32 v95, v95, v39
  v_cvt_pk_bf16_f32 v88, v88, v89
  v_cvt_pk_bf16_f32 v89, v90, v91
  v_cvt_pk_bf16_f32 v90, v92, v93
  v_cvt_pk_bf16_f32 v91, v94, v95
  s_nop 0
  v_permlane16_swap_b32 v88, v90
  v_permlane16_swap_b32 v89, v91
  v_lshlrev_b32 v8, 2, v2
  v_lshlrev_b32 v9, 2, v3
  v_add_u32 v8, 36864, v8
  v_add_u32 v9, 36864, v9
  v_mov_b32 v120, 0x3a924925
  s_barrier
  ds_read_b128 v[24:27], v8 offset:0
  ds_read_b128 v[28:31], v8 offset:16
  ds_read_b128 v[32:35], v8 offset:512
  ds_read_b128 v[36:39], v8 offset:528
  s_waitcnt lgkmcnt(0)
  v_add_f32 v24, v24, v26
  v_add_f32 v25, v25, v27
  v_add_f32 v28, v28, v30
  v_add_f32 v29, v29, v31
  v_add_f32 v32, v32, v34
  v_add_f32 v33, v33, v35
  v_add_f32 v36, v36, v38
  v_add_f32 v37, v37, v39
  v_add_f32 v24, v24, v28
  v_add_f32 v25, v25, v29
  v_add_f32 v32, v32, v36
  v_add_f32 v33, v33, v37
  v_mul_f32 v24, v120, v24
  v_mul_f32 v32, v120, v32
  v_mul_f32 v26, v24, v24
  v_mul_f32 v34, v32, v32
  v_fma_f32 v26, v25, v120, -v26
  v_fma_f32 v34, v33, v120, -v34
  v_max_f32 v26, 0, v26
  v_max_f32 v34, 0, v34
  v_add_f32 v26, 0x3727c5ac, v26
  v_add_f32 v34, 0x3727c5ac, v34
  v_rsq_f32 v16, v26
  v_rsq_f32 v18, v34
  v_mul_f32 v17, -v24, v16
  v_mul_f32 v19, -v32, v18
  v_fma_f32 v96, v96, v16, v17
  v_fma_f32 v97, v97, v16, v17
  v_fma_f32 v98, v98, v16, v17
  v_fma_f32 v99, v99, v16, v17
  v_fma_f32 v100, v100, v18, v19
  v_fma_f32 v101, v101, v18, v19
  v_fma_f32 v102, v102, v18, v19
  v_fma_f32 v103, v103, v18, v19
  v_cvt_pk_bf16_f32 v96, v96, v97
  v_cvt_pk_bf16_f32 v97, v98, v99
  v_cvt_pk_bf16_f32 v98, v100, v101
  v_cvt_pk_bf16_f32 v99, v102, v103
  s_nop 0
  v_permlane16_swap_b32 v96, v98
  v_permlane16_swap_b32 v97, v99
  buffer_store_dwordx4 v[96:99], v6, s[16:19], s54 offen offset:0 sc1
  v_fma_f32 v112, v112, v16, v17
  v_fma_f32 v113, v113, v16, v17
  v_fma_f32 v114, v114, v16, v17
  v_fma_f32 v115, v115, v16, v17
  v_fma_f32 v116, v116, v18, v19
  v_fma_f32 v117, v117, v18, v19
  v_fma_f32 v118, v118, v18, v19
  v_fma_f32 v119, v119, v18, v19
  v_cvt_pk_bf16_f32 v112, v112, v113
  v_cvt_pk_bf16_f32 v113, v114, v115
  v_cvt_pk_bf16_f32 v114, v116, v117
  v_cvt_pk_bf16_f32 v115, v118, v119
  s_nop 0
  v_permlane16_swap_b32 v112, v114
  v_permlane16_swap_b32 v113, v115
  buffer_store_dwordx4 v[112:115], v7, s[16:19], s54 offen offset:1024 sc1
  ds_read_b128 v[24:27], v9 offset:0
  ds_read_b128 v[28:31], v9 offset:16
  ds_read_b128 v[32:35], v9 offset:512
  ds_read_b128 v[36:39], v9 offset:528
  s_waitcnt lgkmcnt(0)
  v_add_f32 v24, v24, v26
  v_add_f32 v25, v25, v27
  v_add_f32 v28, v28, v30
  v_add_f32 v29, v29, v31
  v_add_f32 v32, v32, v34
  v_add_f32 v33, v33, v35
  v_add_f32 v36, v36, v38
  v_add_f32 v37, v37, v39
  v_add_f32 v24, v24, v28
  v_add_f32 v25, v25, v29
  v_add_f32 v32, v32, v36
  v_add_f32 v33, v33, v37
  v_mul_f32 v24, v120, v24
  v_mul_f32 v32, v120, v32
  v_mul_f32 v26, v24, v24
  v_mul_f32 v34, v32, v32
  v_fma_f32 v26, v25, v120, -v26
  v_fma_f32 v34, v33, v120, -v34
  v_max_f32 v26, 0, v26
  v_max_f32 v34, 0, v34
  v_add_f32 v26, 0x3727c5ac, v26
  v_add_f32 v34, 0x3727c5ac, v34
  v_rsq_f32 v20, v26
  v_rsq_f32 v22, v34
  v_mul_f32 v21, -v24, v20
  v_mul_f32 v23, -v32, v22
  v_fma_f32 v104, v104, v20, v21
  v_fma_f32 v105, v105, v20, v21
  v_fma_f32 v106, v106, v20, v21
  v_fma_f32 v107, v107, v20, v21
  v_fma_f32 v108, v108, v22, v23
  v_fma_f32 v109, v109, v22, v23
  v_fma_f32 v110, v110, v22, v23
  v_fma_f32 v111, v111, v22, v23
  v_cvt_pk_bf16_f32 v104, v104, v105
  v_cvt_pk_bf16_f32 v105, v106, v107
  v_cvt_pk_bf16_f32 v106, v108, v109
  v_cvt_pk_bf16_f32 v107, v110, v111
  s_nop 0
  v_permlane16_swap_b32 v104, v106
  v_permlane16_swap_b32 v105, v107
  buffer_store_dwordx4 v[104:107], v6, s[16:19], s55 offen offset:0 sc1
  s_waitcnt vmcnt(0)
  s_barrier
  s_barrier
  buffer_store_dwordx4 v[64:67], v5, s[16:19], s52 offen offset:0 sc1
  buffer_store_dwordx4 v[72:75], v5, s[16:19], s53 offen offset:0 sc1
  buffer_store_dwordx4 v[80:83], v5, s[16:19], s52 offen offset:1024 sc1
  buffer_store_dwordx4 v[88:91], v5, s[16:19], s53 offen offset:1024 sc1
L_Z_cend:
  s_lshl_b32 s36, s33, 1
  s_add_u32 s36, s36, s45
  s_lshl_b32 s36, s36, 4
  s_add_u32 s36, s36, s34
  s_lshl_b32 s36, s36, 1
  s_add_u32 s36, s36, s46
  s_lshl_b32 s36, s36, 7
  s_add_u32 s5, s36, 24182784
L_Z_done:
  s_load_dwordx2 s[8:9], s[0:1], 80
  s_load_dwordx4 s[12:15], s[0:1], 40
  s_load_dwordx4 s[16:19], s[0:1], 56
  s_load_dwordx2 s[20:21], s[0:1], 16
  s_load_dwordx2 s[22:23], s[0:1], 0
  v_lshrrev_b32 v4, 6, v0
  v_and_b32 v1, 63, v0
  v_readfirstlane_b32 s40, v4
  s_and_b32 s50, s3, 7
  s_lshr_b32 s49, s3, 3
  s_lshr_b32 s44, s49, 3
  s_lshl_b32 s41, s50, 2
  s_add_u32 s41, s41, s44
  s_and_b32 s42, s49, 7
  s_waitcnt lgkmcnt(0)
  s_mov_b32 s24, s8
  s_and_b32 s25, s9, 0xffff
  s_mov_b32 s26, 33554432
  s_mov_b32 s27, 0x20000
  s_cmp_ge_u32 s40, 6
  s_cbranch_scc1 L_sp_pref
  s_cmp_ge_u32 s40, 4
  s_cbranch_scc1 L_sp_load
  s_cmp_lg_u32 s42, 7
  s_cbranch_scc1 L_sp_c0
  v_mov_b32 v11, s4
  s_waitcnt vmcnt(0)
  s_mov_b64 exec, 1
  buffer_store_dword v11, off, s[24:27], s5 sc1
  s_mov_b64 exec, -1
L_sp_c0:
  s_setprio 2
  s_cmp_eq_u32 s42, 7
  s_cbranch_scc1 L_sp_cy
  s_mov_b32 s32, s14
  s_and_b32 s33, s15, 0xffff
  s_mov_b32 s34, 4096
  s_mov_b32 s35, 0x20000
  v_lshrrev_b32 v4, 5, v1
  v_bfe_u32 v5, v1, 4, 1
  v_bfe_u32 v6, v1, 1, 1
  v_lshl_add_u32 v5, v5, 1, v6
  v_lshlrev_b32 v6, 1, v4
  v_xor_b32 v6, v6, v5
  v_lshlrev_b32 v12, 8, v5
  v_lshl_add_u32 v12, v6, 6, v12
  v_bfe_u32 v6, v1, 2, 2
  v_lshl_add_u32 v12, v6, 4, v12
  v_and_b32 v6, 1, v1
  v_lshl_add_u32 v12, v6, 3, v12
  s_lshl_b32 s44, s40, 10
  v_add_u32 v12, s44, v12
  v_xor_b32 v13, 64, v12
  v_and_b32 v5, 31, v1
  v_bfe_u32 v6, v1, 1, 3
  v_xor_b32 v6, v6, v4
  v_lshlrev_b32 v8, 7, v5
  v_add_u32 v8, 49152, v8
  v_xor_b32 v7, 0, v6
  v_lshl_add_u32 v14, v7, 4, v8
  v_xor_b32 v7, 2, v6
  v_lshl_add_u32 v15, v7, 4, v8
  v_xor_b32 v7, 4, v6
  v_lshl_add_u32 v16, v7, 4, v8
  v_xor_b32 v7, 6, v6
  v_lshl_add_u32 v17, v7, 4, v8
  s_mul_i32 s44, s41, 114688
  s_lshl_b32 s45, s42, 12
  s_add_u32 s44, s44, s45
  s_lshl_b32 s45, s40, 10
  s_add_u32 s51, s44, s45
  v_bfe_u32 v9, v1, 4, 1
  v_mul_u32_u24 v94, 28672, v9
  v_lshl_add_u32 v94, v4, 8, v94
  v_and_b32 v9, 15, v1
  v_lshl_add_u32 v94, v9, 4, v94
  v_lshlrev_b32 v9, 1, v5
  v_mov_b32 v44, 0
  v_mov_b32 v45, 0
  v_mov_b32 v46, 0
  v_mov_b32 v47, 0
  v_mov_b32 v48, 0
  v_mov_b32 v49, 0
  v_mov_b32 v50, 0
  v_mov_b32 v51, 0
  v_mov_b32 v52, 0
  v_mov_b32 v53, 0
  v_mov_b32 v54, 0
  v_mov_b32 v55, 0
  v_mov_b32 v56, 0
  v_mov_b32 v57, 0
  v_mov_b32 v58, 0
  v_mov_b32 v59, 0
  v_mov_b32 v60, 0
  v_mov_b32 v61, 0
  v_mov_b32 v62, 0
  v_mov_b32 v63, 0
  v_mov_b32 v64, 0
  v_mov_b32 v65, 0
  v_mov_b32 v66, 0
  v_mov_b32 v67, 0
  v_mov_b32 v68, 0
  v_mov_b32 v69, 0
  v_mov_b32 v70, 0
  v_mov_b32 v71, 0
  v_mov_b32 v72, 0
  v_mov_b32 v73, 0
  v_mov_b32 v74, 0
  v_mov_b32 v75, 0
  s_barrier
  ds_read_b64_tr_b16 v[20:21], v12 offset:0
  ds_read_b64_tr_b16 v[22:23], v13 offset:0
  ds_read_b128 v[28:31], v14 offset:0
  ds_read_b128 v[32:35], v14 offset:4096
  s_mov_b32 s48, 0
L_sp_cloop:
  ds_read_b64_tr_b16 v[24:25], v12 offset:4096
  ds_read_b64_tr_b16 v[26:27], v13 offset:4096
  ds_read_b128 v[36:39], v15 offset:0
  ds_read_b128 v[40:43], v15 offset:4096
  s_waitcnt lgkmcnt(4)
  v_mfma_f32_32x32x16_bf16 v[44:59], v[20:23], v[28:31], v[44:59]
  v_mfma_f32_32x32x16_bf16 v[60:75], v[20:23], v[32:35], v[60:75]
  ds_read_b64_tr_b16 v[20:21], v12 offset:8192
  ds_read_b64_tr_b16 v[22:23], v13 offset:8192
  ds_read_b128 v[28:31], v16 offset:0
  ds_read_b128 v[32:35], v16 offset:4096
  s_waitcnt lgkmcnt(4)
  v_mfma_f32_32x32x16_bf16 v[44:59], v[24:27], v[36:39], v[44:59]
  v_mfma_f32_32x32x16_bf16 v[60:75], v[24:27], v[40:43], v[60:75]
  ds_read_b64_tr_b16 v[24:25], v12 offset:12288
  ds_read_b64_tr_b16 v[26:27], v13 offset:12288
  ds_read_b128 v[36:39], v17 offset:0
  ds_read_b128 v[40:43], v17 offset:4096
  s_waitcnt lgkmcnt(4)
  v_mfma_f32_32x32x16_bf16 v[44:59], v[20:23], v[28:31], v[44:59]
  v_mfma_f32_32x32x16_bf16 v[60:75], v[20:23], v[32:35], v[60:75]
  s_waitcnt lgkmcnt(0)
  s_barrier
  ds_read_b64_tr_b16 v[20:21], v12 offset:16384
  ds_read_b64_tr_b16 v[22:23], v13 offset:16384
  ds_read_b128 v[28:31], v14 offset:8192
  ds_read_b128 v[32:35], v14 offset:12288
  v_mfma_f32_32x32x16_bf16 v[44:59], v[24:27], v[36:39], v[44:59]
  v_mfma_f32_32x32x16_bf16 v[60:75], v[24:27], v[40:43], v[60:75]
  ds_read_b64_tr_b16 v[24:25], v12 offset:20480
  ds_read_b64_tr_b16 v[26:27], v13 offset:20480
  ds_read_b128 v[36:39], v15 offset:8192
  ds_read_b128 v[40:43], v15 offset:12288
  s_waitcnt lgkmcnt(4)
  v_mfma_f32_32x32x16_bf16 v[44:59], v[20:23], v[28:31], v[44:59]
  v_mfma_f32_32x32x16_bf16 v[60:75], v[20:23], v[32:35], v[60:75]
  ds_read_b64_tr_b16 v[20:21], v12 offset:24576
  ds_read_b64_tr_b16 v[22:23], v13 offset:24576
  ds_read_b128 v[28:31], v16 offset:8192
  ds_read_b128 v[32:35], v16 offset:12288
  s_waitcnt lgkmcnt(4)
  v_mfma_f32_32x32x16_bf16 v[44:59], v[24:27], v[36:39], v[44:59]
  v_mfma_f32_32x32x16_bf16 v[60:75], v[24:27], v[40:43], v[60:75]
  ds_read_b64_tr_b16 v[24:25], v12 offset:28672
  ds_read_b64_tr_b16 v[26:27], v13 offset:28672
  ds_read_b128 v[36:39], v17 offset:8192
  ds_read_b128 v[40:43], v17 offset:12288
  s_waitcnt lgkmcnt(4)
  v_mfma_f32_32x32x16_bf16 v[44:59], v[20:23], v[28:31], v[44:59]
  v_mfma_f32_32x32x16_bf16 v[60:75], v[20:23], v[32:35], v[60:75]
  s_waitcnt lgkmcnt(0)
  s_barrier
  ds_read_b64_tr_b16 v[20:21], v12 offset:32768
  ds_read_b64_tr_b16 v[22:23], v13 offset:32768
  ds_read_b128 v[28:31], v14 offset:16384
  ds_read_b128 v[32:35], v14 offset:20480
  v_mfma_f32_32x32x16_bf16 v[44:59], v[24:27], v[36:39], v[44:59]
  v_mfma_f32_32x32x16_bf16 v[60:75], v[24:27], v[40:43], v[60:75]
  ds_read_b64_tr_b16 v[24:25], v12 offset:36864
  ds_read_b64_tr_b16 v[26:27], v13 offset:36864
  ds_read_b128 v[36:39], v15 offset:16384
  ds_read_b128 v[40:43], v15 offset:20480
  s_waitcnt lgkmcnt(4)
  v_mfma_f32_32x32x16_bf16 v[44:59], v[20:23], v[28:31], v[44:59]
  v_mfma_f32_32x32x16_bf16 v[60:75], v[20:23], v[32:35], v[60:75]
  ds_read_b64_tr_b16 v[20:21], v12 offset:40960
  ds_read_b64_tr_b16 v[22:23], v13 offset:40960
  ds_read_b128 v[28:31], v16 offset:16384
  ds_read_b128 v[32:35], v16 offset:20480
  s_waitcnt lgkmcnt(4)
  v_mfma_f32_32x32x16_bf16 v[44:59], v[24:27], v[36:39], v[44:59]
  v_mfma_f32_32x32x16_bf16 v[60:75], v[24:27], v[40:43], v[60:75]
  ds_read_b64_tr_b16 v[24:25], v12 offset:45056
  ds_read_b64_tr_b16 v[26:27], v13 offset:45056
  ds_read_b128 v[36:39], v17 offset:16384
  ds_read_b128 v[40:43], v17 offset:20480
  s_waitcnt lgkmcnt(4)
  v_mfma_f32_32x32x16_bf16 v[44:59], v[20:23], v[28:31], v[44:59]
  v_mfma_f32_32x32x16_bf16 v[60:75], v[20:23], v[32:35], v[60:75]
  s_waitcnt lgkmcnt(0)
  s_barrier
  ds_read_b64_tr_b16 v[20:21], v12 offset:0
  ds_read_b64_tr_b16 v[22:23], v13 offset:0
  ds_read_b128 v[28:31], v14 offset:0
  ds_read_b128 v[32:35], v14 offset:4096
  v_mfma_f32_32x32x16_bf16 v[44:59], v[24:27], v[36:39], v[44:59]
  v_mfma_f32_32x32x16_bf16 v[60:75], v[24:27], v[40:43], v[60:75]
  s_cmp_lg_u32 s48, 1
  s_cbranch_scc1 L_sp_c1
  v_mov_b32 v11, s4
  s_waitcnt vmcnt(0)
  s_mov_b64 exec, 1
  buffer_store_dword v11, off, s[24:27], s5 sc1
  s_mov_b64 exec, -1
L_sp_c1:
  s_add_u32 s48, s48, 1
  s_cmp_lt_u32 s48, 10
  s_cbranch_scc1 L_sp_cloop
  s_add_u32 s44, s51, 6291456
  s_add_u32 s45, s44, 57344
  s_lshl_b32 s46, s41, 7
  buffer_load_dwordx4 v[76:79], v94, s[24:27], s44 offen sc1
  buffer_load_dwordx4 v[80:83], v94, s[24:27], s44 offen offset:512 sc1
  buffer_load_dwordx4 v[84:87], v94, s[24:27], s45 offen sc1
  buffer_load_dwordx4 v[88:91], v94, s[24:27], s45 offen offset:512 sc1
  buffer_load_ushort v92, v9, s[32:35], s46 offen
  buffer_load_ushort v93, v9, s[32:35], s46 offen offset:64
  ds_read_b64_tr_b16 v[24:25], v12 offset:4096
  ds_read_b64_tr_b16 v[26:27], v13 offset:4096
  ds_read_b128 v[36:39], v15 offset:0
  ds_read_b128 v[40:43], v15 offset:4096
  s_waitcnt lgkmcnt(4)
  v_mfma_f32_32x32x16_bf16 v[44:59], v[20:23], v[28:31], v[44:59]
  v_mfma_f32_32x32x16_bf16 v[60:75], v[20:23], v[32:35], v[60:75]
  ds_read_b64_tr_b16 v[20:21], v12 offset:8192
  ds_read_b64_tr_b16 v[22:23], v13 offset:8192
  ds_read_b128 v[28:31], v16 offset:0
  ds_read_b128 v[32:35], v16 offset:4096
  s_waitcnt lgkmcnt(4)
  v_mfma_f32_32x32x16_bf16 v[44:59], v[24:27], v[36:39], v[44:59]
  v_mfma_f32_32x32x16_bf16 v[60:75], v[24:27], v[40:43], v[60:75]
  ds_read_b64_tr_b16 v[24:25], v12 offset:12288
  ds_read_b64_tr_b16 v[26:27], v13 offset:12288
  ds_read_b128 v[36:39], v17 offset:0
  ds_read_b128 v[40:43], v17 offset:4096
  s_waitcnt lgkmcnt(4)
  v_mfma_f32_32x32x16_bf16 v[44:59], v[20:23], v[28:31], v[44:59]
  v_mfma_f32_32x32x16_bf16 v[60:75], v[20:23], v[32:35], v[60:75]
  s_waitcnt lgkmcnt(0)
  s_barrier
  ds_read_b64_tr_b16 v[20:21], v12 offset:16384
  ds_read_b64_tr_b16 v[22:23], v13 offset:16384
  ds_read_b128 v[28:31], v14 offset:8192
  ds_read_b128 v[32:35], v14 offset:12288
  v_mfma_f32_32x32x16_bf16 v[44:59], v[24:27], v[36:39], v[44:59]
  v_mfma_f32_32x32x16_bf16 v[60:75], v[24:27], v[40:43], v[60:75]
  ds_read_b64_tr_b16 v[24:25], v12 offset:20480
  ds_read_b64_tr_b16 v[26:27], v13 offset:20480
  ds_read_b128 v[36:39], v15 offset:8192
  ds_read_b128 v[40:43], v15 offset:12288
  s_waitcnt lgkmcnt(4)
  v_mfma_f32_32x32x16_bf16 v[44:59], v[20:23], v[28:31], v[44:59]
  v_mfma_f32_32x32x16_bf16 v[60:75], v[20:23], v[32:35], v[60:75]
  ds_read_b64_tr_b16 v[20:21], v12 offset:24576
  ds_read_b64_tr_b16 v[22:23], v13 offset:24576
  ds_read_b128 v[28:31], v16 offset:8192
  ds_read_b128 v[32:35], v16 offset:12288
  s_waitcnt lgkmcnt(4)
  v_mfma_f32_32x32x16_bf16 v[44:59], v[24:27], v[36:39], v[44:59]
  v_mfma_f32_32x32x16_bf16 v[60:75], v[24:27], v[40:43], v[60:75]
  ds_read_b64_tr_b16 v[24:25], v12 offset:28672
  ds_read_b64_tr_b16 v[26:27], v13 offset:28672
  ds_read_b128 v[36:39], v17 offset:8192
  ds_read_b128 v[40:43], v17 offset:12288
  s_waitcnt lgkmcnt(4)
  v_mfma_f32_32x32x16_bf16 v[44:59], v[20:23], v[28:31], v[44:59]
  v_mfma_f32_32x32x16_bf16 v[60:75], v[20:23], v[32:35], v[60:75]
  s_waitcnt lgkmcnt(0)
  v_mfma_f32_32x32x16_bf16 v[44:59], v[24:27], v[36:39], v[44:59]
  v_mfma_f32_32x32x16_bf16 v[60:75], v[24:27], v[40:43], v[60:75]
  s_barrier
  s_setprio 3
  s_waitcnt vmcnt(0)
  v_lshlrev_b32 v92, 16, v92
  v_lshlrev_b32 v93, 16, v93
  s_add_u32 s44, s51, 25165824
  s_add_u32 s45, s44, 57344
  v_permlane32_swap_b32 v76, v78
  v_permlane32_swap_b32 v77, v79
  v_permlane32_swap_b32 v80, v82
  v_permlane32_swap_b32 v81, v83
  v_permlane32_swap_b32 v84, v86
  v_permlane32_swap_b32 v85, v87
  v_permlane32_swap_b32 v88, v90
  v_permlane32_swap_b32 v89, v91
  v_add_f32 v44, v44, v92
  v_add_f32 v45, v45, v92
  v_add_f32 v46, v46, v92
  v_add_f32 v47, v47, v92
  v_add_f32 v48, v48, v92
  v_add_f32 v49, v49, v92
  v_add_f32 v50, v50, v92
  v_add_f32 v51, v51, v92
  v_add_f32 v52, v52, v92
  v_add_f32 v53, v53, v92
  v_add_f32 v54, v54, v92
  v_add_f32 v55, v55, v92
  v_add_f32 v56, v56, v92
  v_add_f32 v57, v57, v92
  v_add_f32 v58, v58, v92
  v_add_f32 v59, v59, v92
  v_lshlrev_b32 v4, 16, v76
  v_and_b32 v5, 0xffff0000, v76
  v_mul_f32 v44, v44, v4
  v_mul_f32 v45, v45, v5
  v_cvt_pk_bf16_f32 v76, v44, v45
  v_lshlrev_b32 v6, 16, v77
  v_and_b32 v7, 0xffff0000, v77
  v_mul_f32 v46, v46, v6
  v_mul_f32 v47, v47, v7
  v_cvt_pk_bf16_f32 v77, v46, v47
  v_lshlrev_b32 v4, 16, v78
  v_and_b32 v5, 0xffff0000, v78
  v_mul_f32 v48, v48, v4
  v_mul_f32 v49, v49, v5
  v_cvt_pk_bf16_f32 v78, v48, v49
  v_lshlrev_b32 v6, 16, v79
  v_and_b32 v7, 0xffff0000, v79
  v_mul_f32 v50, v50, v6
  v_mul_f32 v51, v51, v7
  v_cvt_pk_bf16_f32 v79, v50, v51
  v_permlane32_swap_b32 v76, v78
  s_nop 0
  v_permlane32_swap_b32 v77, v79
  buffer_store_dwordx4 v[76:79], v94, s[24:27], s44 offen offset:0 sc1
  v_lshlrev_b32 v4, 16, v80
  v_and_b32 v5, 0xffff0000, v80
  v_mul_f32 v52, v52, v4
  v_mul_f32 v53, v53, v5
  v_cvt_pk_bf16_f32 v80, v52, v53
  v_lshlrev_b32 v6, 16, v81
  v_and_b32 v7, 0xffff0000, v81
  v_mul_f32 v54, v54, v6
  v_mul_f32 v55, v55, v7
  v_cvt_pk_bf16_f32 v81, v54, v55
  v_lshlrev_b32 v4, 16, v82
  v_and_b32 v5, 0xffff0000, v82
  v_mul_f32 v56, v56, v4
  v_mul_f32 v57, v57, v5
  v_cvt_pk_bf16_f32 v82, v56, v57
  v_lshlrev_b32 v6, 16, v83
  v_and_b32 v7, 0xffff0000, v83
  v_mul_f32 v58, v58, v6
  v_mul_f32 v59, v59, v7
  v_cvt_pk_bf16_f32 v83, v58, v59
  v_permlane32_swap_b32 v80, v82
  s_nop 0
  v_permlane32_swap_b32 v81, v83
  buffer_store_dwordx4 v[80:83], v94, s[24:27], s44 offen offset:512 sc1
  v_add_f32 v60, v60, v93
  v_add_f32 v61, v61, v93
  v_add_f32 v62, v62, v93
  v_add_f32 v63, v63, v93
  v_add_f32 v64, v64, v93
  v_add_f32 v65, v65, v93
  v_add_f32 v66, v66, v93
  v_add_f32 v67, v67, v93
  v_add_f32 v68, v68, v93
  v_add_f32 v69, v69, v93
  v_add_f32 v70, v70, v93
  v_add_f32 v71, v71, v93
  v_add_f32 v72, v72, v93
  v_add_f32 v73, v73, v93
  v_add_f32 v74, v74, v93
  v_add_f32 v75, v75, v93
  v_lshlrev_b32 v4, 16, v84
  v_and_b32 v5, 0xffff0000, v84
  v_mul_f32 v60, v60, v4
  v_mul_f32 v61, v61, v5
  v_cvt_pk_bf16_f32 v84, v60, v61
  v_lshlrev_b32 v6, 16, v85
  v_and_b32 v7, 0xffff0000, v85
  v_mul_f32 v62, v62, v6
  v_mul_f32 v63, v63, v7
  v_cvt_pk_bf16_f32 v85, v62, v63
  v_lshlrev_b32 v4, 16, v86
  v_and_b32 v5, 0xffff0000, v86
  v_mul_f32 v64, v64, v4
  v_mul_f32 v65, v65, v5
  v_cvt_pk_bf16_f32 v86, v64, v65
  v_lshlrev_b32 v6, 16, v87
  v_and_b32 v7, 0xffff0000, v87
  v_mul_f32 v66, v66, v6
  v_mul_f32 v67, v67, v7
  v_cvt_pk_bf16_f32 v87, v66, v67
  v_permlane32_swap_b32 v84, v86
  s_nop 0
  v_permlane32_swap_b32 v85, v87
  buffer_store_dwordx4 v[84:87], v94, s[24:27], s45 offen offset:0 sc1
  v_lshlrev_b32 v4, 16, v88
  v_and_b32 v5, 0xffff0000, v88
  v_mul_f32 v68, v68, v4
  v_mul_f32 v69, v69, v5
  v_cvt_pk_bf16_f32 v88, v68, v69
  v_lshlrev_b32 v6, 16, v89
  v_and_b32 v7, 0xffff0000, v89
  v_mul_f32 v70, v70, v6
  v_mul_f32 v71, v71, v7
  v_cvt_pk_bf16_f32 v89, v70, v71
  v_lshlrev_b32 v4, 16, v90
  v_and_b32 v5, 0xffff0000, v90
  v_mul_f32 v72, v72, v4
  v_mul_f32 v73, v73, v5
  v_cvt_pk_bf16_f32 v90, v72, v73
  v_lshlrev_b32 v6, 16, v91
  v_and_b32 v7, 0xffff0000, v91
  v_mul_f32 v74, v74, v6
  v_mul_f32 v75, v75, v7
  v_cvt_pk_bf16_f32 v91, v74, v75
  v_permlane32_swap_b32 v88, v90
  s_nop 0
  v_permlane32_swap_b32 v89, v91
  buffer_store_dwordx4 v[88:91], v94, s[24:27], s45 offen offset:512 sc1
  s_waitcnt vmcnt(0)
  s_barrier
  s_setprio 3
L_sp_cy:
  s_mov_b32 s32, s22
  s_and_b32 s33, s23, 0xffff
  s_mov_b32 s34, 2097152
  s_mov_b32 s35, 0x20000
  s_mov_b32 s36, s18
  s_and_b32 s37, s19, 0xffff
  s_mov_b32 s38, 2097152
  s_mov_b32 s39, 0x20000
  s_and_b32 s53, s40, 1
  s_lshr_b32 s54, s40, 1
  v_lshrrev_b32 v4, 5, v1
  v_lshlrev_b32 v5, 10, v4
  v_bfe_u32 v6, v1, 2, 2
  v_lshl_add_u32 v5, v6, 7, v5
  v_bfe_u32 v6, v1, 3, 1
  v_xor_b32 v6, s53, v6
  v_lshl_add_u32 v5, v6, 6, v5
  v_bfe_u32 v7, v1, 4, 1
  v_lshl_add_u32 v5, v7, 5, v5
  v_and_b32 v6, 3, v1
  v_lshl_add_u32 v5, v6, 3, v5
  v_add_u32 v12, 8192, v5
  v_and_b32 v6, 15, v1
  v_lshlrev_b32 v5, 4, v6
  v_lshl_add_u32 v5, v4, 8, v5
  v_lshl_add_u32 v5, v7, 11, v5
  s_lshl_b32 s44, s54, 12
  v_add_u32 v13, s44, v5
  v_and_b32 v6, 31, v1
  v_lshlrev_b32 v16, 10, v6
  v_lshl_add_u32 v16, v4, 4, v16
  s_lshl_b32 s55, s41, 16
  s_lshl_b32 s44, s54, 15
  s_add_u32 s55, s55, s44
  s_lshl_b32 s44, s42, 7
  s_add_u32 s55, s55, s44
  s_lshl_b32 s44, s53, 6
  s_add_u32 s55, s55, s44
  buffer_load_dwordx4 v[116:119], v16, s[32:35], s55 offen
  buffer_load_dwordx4 v[120:123], v16, s[32:35], s55 offen offset:32
  s_mov_b32 s56, 0
  s_mov_b32 s48, 0
  v_mov_b32 v84, 0
  v_mov_b32 v100, 0
  v_mov_b32 v85, 0
  v_mov_b32 v101, 0
  v_mov_b32 v86, 0
  v_mov_b32 v102, 0
  v_mov_b32 v87, 0
  v_mov_b32 v103, 0
  v_mov_b32 v88, 0
  v_mov_b32 v104, 0
  v_mov_b32 v89, 0
  v_mov_b32 v105, 0
  v_mov_b32 v90, 0
  v_mov_b32 v106, 0
  v_mov_b32 v91, 0
  v_mov_b32 v107, 0
  v_mov_b32 v92, 0
  v_mov_b32 v108, 0
  v_mov_b32 v93, 0
  v_mov_b32 v109, 0
  v_mov_b32 v94, 0
  v_mov_b32 v110, 0
  v_mov_b32 v95, 0
  v_mov_b32 v111, 0
  v_mov_b32 v96, 0
  v_mov_b32 v112, 0
  v_mov_b32 v97, 0
  v_mov_b32 v113, 0
  v_mov_b32 v98, 0
  v_mov_b32 v114, 0
  v_mov_b32 v99, 0
  v_mov_b32 v115, 0
  v_add_u32 v14, s56, v12
  v_add_u32 v15, s56, v13
  s_add_u32 s56, s56, 16384
  s_cmp_eq_u32 s56, 81920
  s_cselect_b32 s56, 0, s56
  s_barrier
  ds_read_b64_tr_b16 v[20:21], v14 offset:0
  ds_read_b64_tr_b16 v[22:23], v14 offset:512
  ds_read_b128 v[52:55], v15 offset:0
  ds_read_b64_tr_b16 v[24:25], v14 offset:2048
  ds_read_b64_tr_b16 v[26:27], v14 offset:2560
  ds_read_b128 v[56:59], v15 offset:512
  ds_read_b64_tr_b16 v[28:29], v14 offset:4096
  ds_read_b64_tr_b16 v[30:31], v14 offset:4608
  ds_read_b128 v[60:63], v15 offset:1024
  ds_read_b64_tr_b16 v[32:33], v14 offset:6144
  ds_read_b64_tr_b16 v[34:35], v14 offset:6656
  ds_read_b128 v[64:67], v15 offset:1536
L_sp_ly:
  s_waitcnt lgkmcnt(0)
  v_add_u32 v14, s56, v12
  v_add_u32 v15, s56, v13
  s_add_u32 s56, s56, 16384
  s_cmp_eq_u32 s56, 81920
  s_cselect_b32 s56, 0, s56
  v_mfma_f32_32x32x16_bf16 v[84:99], v[20:23], v[52:55], v[84:99]
  s_barrier
  ds_read_b64_tr_b16 v[36:37], v14 offset:0
  ds_read_b64_tr_b16 v[38:39], v14 offset:512
  ds_read_b128 v[68:71], v15 offset:0
  ds_read_b64_tr_b16 v[40:41], v14 offset:2048
  v_mfma_f32_32x32x16_bf16 v[84:99], v[24:27], v[56:59], v[84:99]
  ds_read_b64_tr_b16 v[42:43], v14 offset:2560
  ds_read_b128 v[72:75], v15 offset:512
  ds_read_b64_tr_b16 v[44:45], v14 offset:4096
  ds_read_b64_tr_b16 v[46:47], v14 offset:4608
  v_mfma_f32_32x32x16_bf16 v[84:99], v[28:31], v[60:63], v[84:99]
  ds_read_b128 v[76:79], v15 offset:1024
  ds_read_b64_tr_b16 v[48:49], v14 offset:6144
  ds_read_b64_tr_b16 v[50:51], v14 offset:6656
  ds_read_b128 v[80:83], v15 offset:1536
  v_mfma_f32_32x32x16_bf16 v[84:99], v[32:35], v[64:67], v[84:99]
  s_waitcnt lgkmcnt(0)
  v_add_u32 v14, s56, v12
  v_add_u32 v15, s56, v13
  s_add_u32 s56, s56, 16384
  s_cmp_eq_u32 s56, 81920
  s_cselect_b32 s56, 0, s56
  v_mfma_f32_32x32x16_bf16 v[84:99], v[36:39], v[68:71], v[84:99]
  s_barrier
  ds_read_b64_tr_b16 v[20:21], v14 offset:0
  ds_read_b64_tr_b16 v[22:23], v14 offset:512
  ds_read_b128 v[52:55], v15 offset:0
  ds_read_b64_tr_b16 v[24:25], v14 offset:2048
  v_mfma_f32_32x32x16_bf16 v[84:99], v[40:43], v[72:75], v[84:99]
  ds_read_b64_tr_b16 v[26:27], v14 offset:2560
  ds_read_b128 v[56:59], v15 offset:512
  ds_read_b64_tr_b16 v[28:29], v14 offset:4096
  ds_read_b64_tr_b16 v[30:31], v14 offset:4608
  v_mfma_f32_32x32x16_bf16 v[84:99], v[44:47], v[76:79], v[84:99]
  ds_read_b128 v[60:63], v15 offset:1024
  ds_read_b64_tr_b16 v[32:33], v14 offset:6144
  ds_read_b64_tr_b16 v[34:35], v14 offset:6656
  ds_read_b128 v[64:67], v15 offset:1536
  v_mfma_f32_32x32x16_bf16 v[84:99], v[48:51], v[80:83], v[84:99]
  s_add_u32 s48, s48, 1
  s_cmp_lt_u32 s48, 6
  s_cbranch_scc1 L_sp_ly
  s_waitcnt lgkmcnt(0)
  v_add_u32 v14, s56, v12
  v_add_u32 v15, s56, v13
  s_add_u32 s56, s56, 16384
  s_cmp_eq_u32 s56, 81920
  s_cselect_b32 s56, 0, s56
  v_mfma_f32_32x32x16_bf16 v[84:99], v[20:23], v[52:55], v[84:99]
  s_barrier
  ds_read_b64_tr_b16 v[36:37], v14 offset:0
  ds_read_b64_tr_b16 v[38:39], v14 offset:512
  ds_read_b128 v[68:71], v15 offset:0
  ds_read_b64_tr_b16 v[40:41], v14 offset:2048
  v_mfma_f32_32x32x16_bf16 v[84:99], v[24:27], v[56:59], v[84:99]
  ds_read_b64_tr_b16 v[42:43], v14 offset:2560
  ds_read_b128 v[72:75], v15 offset:512
  ds_read_b64_tr_b16 v[44:45], v14 offset:4096
  ds_read_b64_tr_b16 v[46:47], v14 offset:4608
  v_mfma_f32_32x32x16_bf16 v[84:99], v[28:31], v[60:63], v[84:99]
  ds_read_b128 v[76:79], v15 offset:1024
  ds_read_b64_tr_b16 v[48:49], v14 offset:6144
  ds_read_b64_tr_b16 v[50:51], v14 offset:6656
  ds_read_b128 v[80:83], v15 offset:1536
  v_mfma_f32_32x32x16_bf16 v[84:99], v[32:35], v[64:67], v[84:99]
  s_waitcnt lgkmcnt(0)
  v_mfma_f32_32x32x16_bf16 v[84:99], v[36:39], v[68:71], v[84:99]
  v_mfma_f32_32x32x16_bf16 v[84:99], v[40:43], v[72:75], v[84:99]
  v_mfma_f32_32x32x16_bf16 v[84:99], v[44:47], v[76:79], v[84:99]
  v_mfma_f32_32x32x16_bf16 v[84:99], v[48:51], v[80:83], v[84:99]
  s_mov_b32 s46, 0xbfb8aa3b
  s_nop 7
  s_nop 3
  v_mul_f32 v20, s46, v84
  v_mul_f32 v21, s46, v85
  v_mul_f32 v22, s46, v86
  v_mul_f32 v23, s46, v87
  v_mul_f32 v24, s46, v88
  v_mul_f32 v25, s46, v89
  v_mul_f32 v26, s46, v90
  v_mul_f32 v27, s46, v91
  v_mul_f32 v28, s46, v92
  v_mul_f32 v29, s46, v93
  v_mul_f32 v30, s46, v94
  v_mul_f32 v31, s46, v95
  v_mul_f32 v32, s46, v96
  v_mul_f32 v33, s46, v97
  v_mul_f32 v34, s46, v98
  v_mul_f32 v35, s46, v99
  v_exp_f32 v20, v20
  v_exp_f32 v21, v21
  v_exp_f32 v22, v22
  v_exp_f32 v23, v23
  v_exp_f32 v24, v24
  v_exp_f32 v25, v25
  v_exp_f32 v26, v26
  v_exp_f32 v27, v27
  v_exp_f32 v28, v28
  v_exp_f32 v29, v29
  v_exp_f32 v30, v30
  v_exp_f32 v31, v31
  v_exp_f32 v32, v32
  v_exp_f32 v33, v33
  v_exp_f32 v34, v34
  v_exp_f32 v35, v35
  v_add_f32 v20, 1.0, v20
  v_add_f32 v21, 1.0, v21
  v_add_f32 v22, 1.0, v22
  v_add_f32 v23, 1.0, v23
  v_add_f32 v24, 1.0, v24
  v_add_f32 v25, 1.0, v25
  v_add_f32 v26, 1.0, v26
  v_add_f32 v27, 1.0, v27
  v_add_f32 v28, 1.0, v28
  v_add_f32 v29, 1.0, v29
  v_add_f32 v30, 1.0, v30
  v_add_f32 v31, 1.0, v31
  v_add_f32 v32, 1.0, v32
  v_add_f32 v33, 1.0, v33
  v_add_f32 v34, 1.0, v34
  v_add_f32 v35, 1.0, v35
  v_rcp_f32 v20, v20
  v_rcp_f32 v21, v21
  v_rcp_f32 v22, v22
  v_rcp_f32 v23, v23
  v_rcp_f32 v24, v24
  v_rcp_f32 v25, v25
  v_rcp_f32 v26, v26
  v_rcp_f32 v27, v27
  v_rcp_f32 v28, v28
  v_rcp_f32 v29, v29
  v_rcp_f32 v30, v30
  v_rcp_f32 v31, v31
  v_rcp_f32 v32, v32
  v_rcp_f32 v33, v33
  v_rcp_f32 v34, v34
  v_rcp_f32 v35, v35
  v_mul_f32 v84, v20, v84
  v_mul_f32 v85, v21, v85
  v_mul_f32 v86, v22, v86
  v_mul_f32 v87, v23, v87
  v_mul_f32 v88, v24, v88
  v_mul_f32 v89, v25, v89
  v_mul_f32 v90, v26, v90
  v_mul_f32 v91, v27, v91
  v_mul_f32 v92, v28, v92
  v_mul_f32 v93, v29, v93
  v_mul_f32 v94, v30, v94
  v_mul_f32 v95, v31, v95
  v_mul_f32 v96, v32, v96
  v_mul_f32 v97, v33, v97
  v_mul_f32 v98, v34, v98
  v_mul_f32 v99, v35, v99
  s_waitcnt vmcnt(0)
  v_permlane32_swap_b32 v116, v118
  v_permlane32_swap_b32 v117, v119
  v_permlane32_swap_b32 v120, v122
  v_permlane32_swap_b32 v121, v123
  s_setprio 3
  v_add_u32 v14, s56, v12
  v_add_u32 v15, s56, v13
  s_add_u32 s56, s56, 16384
  s_cmp_eq_u32 s56, 81920
  s_cselect_b32 s56, 0, s56
  s_barrier
  ds_read_b64_tr_b16 v[20:21], v14 offset:0
  ds_read_b64_tr_b16 v[22:23], v14 offset:512
  ds_read_b128 v[52:55], v15 offset:0
  ds_read_b64_tr_b16 v[24:25], v14 offset:2048
  ds_read_b64_tr_b16 v[26:27], v14 offset:2560
  ds_read_b128 v[56:59], v15 offset:512
  ds_read_b64_tr_b16 v[28:29], v14 offset:4096
  ds_read_b64_tr_b16 v[30:31], v14 offset:4608
  ds_read_b128 v[60:63], v15 offset:1024
  ds_read_b64_tr_b16 v[32:33], v14 offset:6144
  ds_read_b64_tr_b16 v[34:35], v14 offset:6656
  ds_read_b128 v[64:67], v15 offset:1536
  s_mov_b32 s48, 0
L_sp_lo:
  s_waitcnt lgkmcnt(0)
  v_add_u32 v14, s56, v12
  v_add_u32 v15, s56, v13
  s_add_u32 s56, s56, 16384
  s_cmp_eq_u32 s56, 81920
  s_cselect_b32 s56, 0, s56
  v_mfma_f32_32x32x16_bf16 v[100:115], v[20:23], v[52:55], v[100:115]
  s_barrier
  ds_read_b64_tr_b16 v[36:37], v14 offset:0
  ds_read_b64_tr_b16 v[38:39], v14 offset:512
  ds_read_b128 v[68:71], v15 offset:0
  ds_read_b64_tr_b16 v[40:41], v14 offset:2048
  v_mfma_f32_32x32x16_bf16 v[100:115], v[24:27], v[56:59], v[100:115]
  ds_read_b64_tr_b16 v[42:43], v14 offset:2560
  ds_read_b128 v[72:75], v15 offset:512
  ds_read_b64_tr_b16 v[44:45], v14 offset:4096
  ds_read_b64_tr_b16 v[46:47], v14 offset:4608
  v_mfma_f32_32x32x16_bf16 v[100:115], v[28:31], v[60:63], v[100:115]
  ds_read_b128 v[76:79], v15 offset:1024
  ds_read_b64_tr_b16 v[48:49], v14 offset:6144
  ds_read_b64_tr_b16 v[50:51], v14 offset:6656
  ds_read_b128 v[80:83], v15 offset:1536
  v_mfma_f32_32x32x16_bf16 v[100:115], v[32:35], v[64:67], v[100:115]
  s_waitcnt lgkmcnt(0)
  v_add_u32 v14, s56, v12
  v_add_u32 v15, s56, v13
  s_add_u32 s56, s56, 16384
  s_cmp_eq_u32 s56, 81920
  s_cselect_b32 s56, 0, s56
  v_mfma_f32_32x32x16_bf16 v[100:115], v[36:39], v[68:71], v[100:115]
  s_barrier
  ds_read_b64_tr_b16 v[20:21], v14 offset:0
  ds_read_b64_tr_b16 v[22:23], v14 offset:512
  ds_read_b128 v[52:55], v15 offset:0
  ds_read_b64_tr_b16 v[24:25], v14 offset:2048
  v_mfma_f32_32x32x16_bf16 v[100:115], v[40:43], v[72:75], v[100:115]
  ds_read_b64_tr_b16 v[26:27], v14 offset:2560
  ds_read_b128 v[56:59], v15 offset:512
  ds_read_b64_tr_b16 v[28:29], v14 offset:4096
  ds_read_b64_tr_b16 v[30:31], v14 offset:4608
  v_mfma_f32_32x32x16_bf16 v[100:115], v[44:47], v[76:79], v[100:115]
  ds_read_b128 v[60:63], v15 offset:1024
  ds_read_b64_tr_b16 v[32:33], v14 offset:6144
  ds_read_b64_tr_b16 v[34:35], v14 offset:6656
  ds_read_b128 v[64:67], v15 offset:1536
  v_mfma_f32_32x32x16_bf16 v[100:115], v[48:51], v[80:83], v[100:115]
  s_add_u32 s48, s48, 1
  s_cmp_lt_u32 s48, 3
  s_cbranch_scc1 L_sp_lo
  s_waitcnt lgkmcnt(0)
  v_add_u32 v14, s56, v12
  v_add_u32 v15, s56, v13
  s_add_u32 s56, s56, 16384
  s_cmp_eq_u32 s56, 81920
  s_cselect_b32 s56, 0, s56
  v_mfma_f32_32x32x16_bf16 v[100:115], v[20:23], v[52:55], v[100:115]
  s_barrier
  ds_read_b64_tr_b16 v[36:37], v14 offset:0
  ds_read_b64_tr_b16 v[38:39], v14 offset:512
  ds_read_b128 v[68:71], v15 offset:0
  ds_read_b64_tr_b16 v[40:41], v14 offset:2048
  v_mfma_f32_32x32x16_bf16 v[100:115], v[24:27], v[56:59], v[100:115]
  ds_read_b64_tr_b16 v[42:43], v14 offset:2560
  ds_read_b128 v[72:75], v15 offset:512
  ds_read_b64_tr_b16 v[44:45], v14 offset:4096
  ds_read_b64_tr_b16 v[46:47], v14 offset:4608
  v_mfma_f32_32x32x16_bf16 v[100:115], v[28:31], v[60:63], v[100:115]
  ds_read_b128 v[76:79], v15 offset:1024
  ds_read_b64_tr_b16 v[48:49], v14 offset:6144
  ds_read_b64_tr_b16 v[50:51], v14 offset:6656
  ds_read_b128 v[80:83], v15 offset:1536
  v_mfma_f32_32x32x16_bf16 v[100:115], v[32:35], v[64:67], v[100:115]
  s_waitcnt lgkmcnt(0)
  v_mfma_f32_32x32x16_bf16 v[100:115], v[36:39], v[68:71], v[100:115]
  v_mfma_f32_32x32x16_bf16 v[100:115], v[40:43], v[72:75], v[100:115]
  v_mfma_f32_32x32x16_bf16 v[100:115], v[44:47], v[76:79], v[100:115]
  v_mfma_f32_32x32x16_bf16 v[100:115], v[48:51], v[80:83], v[100:115]
  v_lshlrev_b32 v20, 16, v116
  v_and_b32 v21, 0xffff0000, v116
  v_lshlrev_b32 v22, 16, v117
  v_and_b32 v23, 0xffff0000, v117
  v_lshlrev_b32 v24, 16, v118
  v_and_b32 v25, 0xffff0000, v118
  v_lshlrev_b32 v26, 16, v119
  v_and_b32 v27, 0xffff0000, v119
  v_lshlrev_b32 v28, 16, v120
  v_and_b32 v29, 0xffff0000, v120
  v_lshlrev_b32 v30, 16, v121
  v_and_b32 v31, 0xffff0000, v121
  v_lshlrev_b32 v32, 16, v122
  v_and_b32 v33, 0xffff0000, v122
  v_lshlrev_b32 v34, 16, v123
  v_and_b32 v35, 0xffff0000, v123
  v_fma_f32 v100, v100, v84, v20
  v_fma_f32 v101, v101, v85, v21
  v_fma_f32 v102, v102, v86, v22
  v_fma_f32 v103, v103, v87, v23
  v_fma_f32 v104, v104, v88, v24
  v_fma_f32 v105, v105, v89, v25
  v_fma_f32 v106, v106, v90, v26
  v_fma_f32 v107, v107, v91, v27
  v_cvt_pk_bf16_f32 v116, v100, v101
  v_cvt_pk_bf16_f32 v117, v102, v103
  v_cvt_pk_bf16_f32 v118, v104, v105
  v_cvt_pk_bf16_f32 v119, v106, v107
  s_nop 0
  v_permlane32_swap_b32 v116, v118
  v_permlane32_swap_b32 v117, v119
  buffer_store_dwordx4 v[116:119], v16, s[36:39], s55 offen offset:0
  v_fma_f32 v108, v108, v92, v28
  v_fma_f32 v109, v109, v93, v29
  v_fma_f32 v110, v110, v94, v30
  v_fma_f32 v111, v111, v95, v31
  v_fma_f32 v112, v112, v96, v32
  v_fma_f32 v113, v113, v97, v33
  v_fma_f32 v114, v114, v98, v34
  v_fma_f32 v115, v115, v99, v35
  v_cvt_pk_bf16_f32 v120, v108, v109
  v_cvt_pk_bf16_f32 v121, v110, v111
  v_cvt_pk_bf16_f32 v122, v112, v113
  v_cvt_pk_bf16_f32 v123, v114, v115
  s_nop 0
  v_permlane32_swap_b32 v120, v122
  v_permlane32_swap_b32 v121, v123
  buffer_store_dwordx4 v[120:123], v16, s[36:39], s55 offen offset:32
  s_or_b32 s44, s3, s40
  s_cmp_lg_u32 s44, 0
  s_cbranch_scc1 L_sp_ne
  v_mov_b32 v4, s4
  s_mov_b32 s44, 21757952
  s_mov_b64 exec, 1
  buffer_store_dword v4, off, s[24:27], s44 sc1
L_sp_ne:
  s_endpgm
L_sp_load:
  s_mov_b32 s28, s12
  s_and_b32 s29, s13, 0xffff
  s_mov_b32 s30, 8388608
  s_mov_b32 s31, 0x20000
  s_mov_b32 s32, s16
  s_and_b32 s33, s17, 0xffff
  s_mov_b32 s34, 917504
  s_mov_b32 s35, 0x20000
  s_mov_b32 s36, s20
  s_and_b32 s37, s21, 0xffff
  s_mov_b32 s38, 524288
  s_mov_b32 s39, 0x20000
  s_setprio 3
  v_lshlrev_b32 v8, 4, v1
  v_lshrrev_b32 v4, 4, v1
  v_lshrrev_b32 v5, 3, v1
  v_and_b32 v6, 7, v1
  v_xor_b32 v7, v6, v4
  v_lshlrev_b32 v7, 4, v7
  v_lshl_add_u32 v9, v5, 12, v7
  v_xor_b32 v10, 64, v9
  v_bfe_u32 v7, v1, 4, 1
  v_lshlrev_b32 v7, 2, v7
  v_xor_b32 v7, v7, v6
  v_lshlrev_b32 v7, 4, v7
  v_lshl_add_u32 v11, v5, 10, v7
  s_sub_u32 s58, s40, 4
  s_cmp_eq_u32 s42, 7
  s_cbranch_scc1 L_sp_lsp
  s_mul_i32 s56, s58, 57344
  s_lshl_b32 s45, s42, 12
  s_add_u32 s56, s56, s45
  s_add_u32 s56, s56, 10485760
  s_lshl_b32 s57, s41, 18
  s_lshl_b32 s45, s58, 17
  s_add_u32 s57, s57, s45
  s_lshl_b32 s53, s58, 13
  s_lshl_b32 s54, s58, 12
  s_add_u32 s54, s54, 49152
  s_lshl_b32 s55, s50, 2
  s_lshl_b32 s44, s42, 1
  s_add_u32 s45, s44, 1
  s_cmp_eq_u32 s42, 4
  s_cmov_b32 s44, 8
  s_cmov_b32 s45, 10
  s_cmp_eq_u32 s42, 5
  s_cmov_b32 s44, 10
  s_cmov_b32 s45, 13
  s_cmp_eq_u32 s42, 6
  s_cmov_b32 s44, 13
  s_cmov_b32 s45, 15
  v_lshrrev_b32 v17, 4, v1
  v_add_u32 v17, s44, v17
  v_min_u32 v17, s45, v17
  v_and_b32 v16, 15, v1
  v_lshl_add_u32 v17, v17, 4, v16
  v_lshlrev_b32 v17, 7, v17
  s_mov_b32 s47, 24150016
  s_mov_b32 s48, 0
  s_mul_i32 s45, s55, 114688
  s_add_u32 s51, s56, s45
  s_lshl_b32 s45, s55, 7
  s_add_u32 s52, s57, s45
  s_add_u32 s55, s55, 1
  s_and_b32 s55, s55, 31
  buffer_load_dword v16, v17, s[24:27], s47 offen sc1
  s_waitcnt vmcnt(0)
  v_cmp_ne_u32 vcc, s4, v16
  s_cbranch_vccz L_sp_pzd
L_sp_pz:
  buffer_load_dword v16, v17, s[24:27], s47 offen sc1
  s_waitcnt vmcnt(0)
  v_cmp_ne_u32 vcc, s4, v16
  s_add_u32 s48, s48, 1
  s_cbranch_vccz L_sp_pzd
  s_cmp_gt_u32 s48, 0x200000
  s_cbranch_scc1 L_sp_pzd
  s_sleep 1
  s_branch L_sp_pz
L_sp_pzd:
  s_add_u32 m0, s54, 0
  s_add_u32 s46, s52, 0
  buffer_load_dwordx4 v9, s[28:31], s46 offen lds
  s_add_u32 m0, s54, 1024
  s_add_u32 s46, s52, 32768
  buffer_load_dwordx4 v10, s[28:31], s46 offen lds
  s_add_u32 m0, s54, 2048
  s_add_u32 s46, s52, 65536
  buffer_load_dwordx4 v9, s[28:31], s46 offen lds
  s_add_u32 m0, s54, 3072
  s_add_u32 s46, s52, 98304
  buffer_load_dwordx4 v10, s[28:31], s46 offen lds
  s_add_u32 m0, s54, 8192
  s_add_u32 s46, s52, 128
  buffer_load_dwordx4 v9, s[28:31], s46 offen lds
  s_add_u32 m0, s54, 9216
  s_add_u32 s46, s52, 32896
  buffer_load_dwordx4 v10, s[28:31], s46 offen lds
  s_add_u32 m0, s54, 10240
  s_add_u32 s46, s52, 65664
  buffer_load_dwordx4 v9, s[28:31], s46 offen lds
  s_add_u32 m0, s54, 11264
  s_add_u32 s46, s52, 98432
  buffer_load_dwordx4 v10, s[28:31], s46 offen lds
  s_add_u32 m0, s53, 0
  s_add_u32 s46, s51, 0
  buffer_load_dwordx4 v8, s[24:27], s46 offen offset:0 sc1 lds
  buffer_load_dwordx4 v8, s[24:27], s46 offen offset:1024 sc1 lds
  buffer_load_dwordx4 v8, s[24:27], s46 offen offset:2048 sc1 lds
  buffer_load_dwordx4 v8, s[24:27], s46 offen offset:3072 sc1 lds
  s_add_u32 m0, s53, 4096
  s_add_u32 s46, s51, 28672
  buffer_load_dwordx4 v8, s[24:27], s46 offen offset:0 sc1 lds
  buffer_load_dwordx4 v8, s[24:27], s46 offen offset:1024 sc1 lds
  buffer_load_dwordx4 v8, s[24:27], s46 offen offset:2048 sc1 lds
  buffer_load_dwordx4 v8, s[24:27], s46 offen offset:3072 sc1 lds
  s_add_u32 m0, s53, 16384
  s_add_u32 s46, s51, 114688
  buffer_load_dwordx4 v8, s[24:27], s46 offen offset:0 sc1 lds
  buffer_load_dwordx4 v8, s[24:27], s46 offen offset:1024 sc1 lds
  buffer_load_dwordx4 v8, s[24:27], s46 offen offset:2048 sc1 lds
  buffer_load_dwordx4 v8, s[24:27], s46 offen offset:3072 sc1 lds
  s_add_u32 m0, s53, 20480
  s_add_u32 s46, s51, 143360
  buffer_load_dwordx4 v8, s[24:27], s46 offen offset:0 sc1 lds
  buffer_load_dwordx4 v8, s[24:27], s46 offen offset:1024 sc1 lds
  buffer_load_dwordx4 v8, s[24:27], s46 offen offset:2048 sc1 lds
  buffer_load_dwordx4 v8, s[24:27], s46 offen offset:3072 sc1 lds
  s_barrier
  s_add_u32 s55, s55, 1
  s_waitcnt vmcnt(8)
  s_barrier
  s_mul_i32 s45, s55, 114688
  s_add_u32 s51, s56, s45
  s_lshl_b32 s45, s55, 7
  s_add_u32 s52, s57, s45
  s_add_u32 s55, s55, 1
  s_and_b32 s55, s55, 31
  s_add_u32 m0, s53, 32768
  s_add_u32 s46, s51, 0
  buffer_load_dwordx4 v8, s[24:27], s46 offen offset:0 sc1 lds
  buffer_load_dwordx4 v8, s[24:27], s46 offen offset:1024 sc1 lds
  buffer_load_dwordx4 v8, s[24:27], s46 offen offset:2048 sc1 lds
  buffer_load_dwordx4 v8, s[24:27], s46 offen offset:3072 sc1 lds
  s_add_u32 m0, s53, 36864
  s_add_u32 s46, s51, 28672
  buffer_load_dwordx4 v8, s[24:27], s46 offen offset:0 sc1 lds
  buffer_load_dwordx4 v8, s[24:27], s46 offen offset:1024 sc1 lds
  buffer_load_dwordx4 v8, s[24:27], s46 offen offset:2048 sc1 lds
  buffer_load_dwordx4 v8, s[24:27], s46 offen offset:3072 sc1 lds
  s_add_u32 m0, s54, 16384
  s_add_u32 s46, s52, 0
  buffer_load_dwordx4 v9, s[28:31], s46 offen lds
  s_add_u32 m0, s54, 17408
  s_add_u32 s46, s52, 32768
  buffer_load_dwordx4 v10, s[28:31], s46 offen lds
  s_add_u32 m0, s54, 18432
  s_add_u32 s46, s52, 65536
  buffer_load_dwordx4 v9, s[28:31], s46 offen lds
  s_add_u32 m0, s54, 19456
  s_add_u32 s46, s52, 98304
  buffer_load_dwordx4 v10, s[28:31], s46 offen lds
  v_and_b32 v17, 31, v1
  v_lshlrev_b32 v17, 7, v17
  s_lshl_b32 s47, s41, 12
  s_lshl_b32 s44, s42, 31
  s_and_b32 s44, s44, 0xffff
  s_add_u32 s47, s47, s44
  s_add_u32 s47, s47, 24182784
  s_waitcnt vmcnt(12)
  s_barrier
  s_mul_i32 s45, s55, 114688
  s_add_u32 s51, s56, s45
  s_lshl_b32 s45, s55, 7
  s_add_u32 s52, s57, s45
  s_add_u32 s55, s55, 1
  s_and_b32 s55, s55, 31
  s_add_u32 m0, s53, 0
  s_add_u32 s46, s51, 0
  buffer_load_dwordx4 v8, s[24:27], s46 offen offset:0 sc1 lds
  buffer_load_dwordx4 v8, s[24:27], s46 offen offset:1024 sc1 lds
  buffer_load_dwordx4 v8, s[24:27], s46 offen offset:2048 sc1 lds
  buffer_load_dwordx4 v8, s[24:27], s46 offen offset:3072 sc1 lds
  s_add_u32 m0, s53, 4096
  s_add_u32 s46, s51, 28672
  buffer_load_dwordx4 v8, s[24:27], s46 offen offset:0 sc1 lds
  buffer_load_dwordx4 v8, s[24:27], s46 offen offset:1024 sc1 lds
  buffer_load_dwordx4 v8, s[24:27], s46 offen offset:2048 sc1 lds
  buffer_load_dwordx4 v8, s[24:27], s46 offen offset:3072 sc1 lds
  s_add_u32 m0, s54, 0
  s_add_u32 s46, s52, 0
  buffer_load_dwordx4 v9, s[28:31], s46 offen lds
  s_add_u32 m0, s54, 1024
  s_add_u32 s46, s52, 32768
  buffer_load_dwordx4 v10, s[28:31], s46 offen lds
  s_add_u32 m0, s54, 2048
  s_add_u32 s46, s52, 65536
  buffer_load_dwordx4 v9, s[28:31], s46 offen lds
  s_add_u32 m0, s54, 3072
  s_add_u32 s46, s52, 98304
  buffer_load_dwordx4 v10, s[28:31], s46 offen lds
  s_waitcnt vmcnt(12)
  s_barrier
  s_mul_i32 s45, s55, 114688
  s_add_u32 s51, s56, s45
  s_lshl_b32 s45, s55, 7
  s_add_u32 s52, s57, s45
  s_add_u32 s55, s55, 1
  s_and_b32 s55, s55, 31
  s_add_u32 m0, s53, 16384
  s_add_u32 s46, s51, 0
  buffer_load_dwordx4 v8, s[24:27], s46 offen offset:0 sc1 lds
  buffer_load_dwordx4 v8, s[24:27], s46 offen offset:1024 sc1 lds
  buffer_load_dwordx4 v8, s[24:27], s46 offen offset:2048 sc1 lds
  buffer_load_dwordx4 v8, s[24:27], s46 offen offset:3072 sc1 lds
  s_add_u32 m0, s53, 20480
  s_add_u32 s46, s51, 28672
  buffer_load_dwordx4 v8, s[24:27], s46 offen offset:0 sc1 lds
  buffer_load_dwordx4 v8, s[24:27], s46 offen offset:1024 sc1 lds
  buffer_load_dwordx4 v8, s[24:27], s46 offen offset:2048 sc1 lds
  buffer_load_dwordx4 v8, s[24:27], s46 offen offset:3072 sc1 lds
  s_add_u32 m0, s54, 8192
  s_add_u32 s46, s52, 0
  buffer_load_dwordx4 v9, s[28:31], s46 offen lds
  s_add_u32 m0, s54, 9216
  s_add_u32 s46, s52, 32768
  buffer_load_dwordx4 v10, s[28:31], s46 offen lds
  s_add_u32 m0, s54, 10240
  s_add_u32 s46, s52, 65536
  buffer_load_dwordx4 v9, s[28:31], s46 offen lds
  s_add_u32 m0, s54, 11264
  s_add_u32 s46, s52, 98304
  buffer_load_dwordx4 v10, s[28:31], s46 offen lds
  s_mov_b32 s48, 1
L_sp_lloop:
  s_waitcnt vmcnt(12)
  s_barrier
  s_mul_i32 s45, s55, 114688
  s_add_u32 s51, s56, s45
  s_lshl_b32 s45, s55, 7
  s_add_u32 s52, s57, s45
  s_add_u32 s55, s55, 1
  s_and_b32 s55, s55, 31
  s_add_u32 m0, s53, 32768
  s_add_u32 s46, s51, 0
  buffer_load_dwordx4 v8, s[24:27], s46 offen offset:0 sc1 lds
  buffer_load_dwordx4 v8, s[24:27], s46 offen offset:1024 sc1 lds
  buffer_load_dwordx4 v8, s[24:27], s46 offen offset:2048 sc1 lds
  buffer_load_dwordx4 v8, s[24:27], s46 offen offset:3072 sc1 lds
  s_add_u32 m0, s53, 36864
  s_add_u32 s46, s51, 28672
  buffer_load_dwordx4 v8, s[24:27], s46 offen offset:0 sc1 lds
  buffer_load_dwordx4 v8, s[24:27], s46 offen offset:1024 sc1 lds
  buffer_load_dwordx4 v8, s[24:27], s46 offen offset:2048 sc1 lds
  buffer_load_dwordx4 v8, s[24:27], s46 offen offset:3072 sc1 lds
  s_add_u32 m0, s54, 16384
  s_add_u32 s46, s52, 0
  buffer_load_dwordx4 v9, s[28:31], s46 offen lds
  s_add_u32 m0, s54, 17408
  s_add_u32 s46, s52, 32768
  buffer_load_dwordx4 v10, s[28:31], s46 offen lds
  s_add_u32 m0, s54, 18432
  s_add_u32 s46, s52, 65536
  buffer_load_dwordx4 v9, s[28:31], s46 offen lds
  s_add_u32 m0, s54, 19456
  s_add_u32 s46, s52, 98304
  buffer_load_dwordx4 v10, s[28:31], s46 offen lds
  s_waitcnt vmcnt(12)
  s_barrier
  s_mul_i32 s45, s55, 114688
  s_add_u32 s51, s56, s45
  s_lshl_b32 s45, s55, 7
  s_add_u32 s52, s57, s45
  s_add_u32 s55, s55, 1
  s_and_b32 s55, s55, 31
  s_add_u32 m0, s53, 0
  s_add_u32 s46, s51, 0
  buffer_load_dwordx4 v8, s[24:27], s46 offen offset:0 sc1 lds
  buffer_load_dwordx4 v8, s[24:27], s46 offen offset:1024 sc1 lds
  buffer_load_dwordx4 v8, s[24:27], s46 offen offset:2048 sc1 lds
  buffer_load_dwordx4 v8, s[24:27], s46 offen offset:3072 sc1 lds
  s_add_u32 m0, s53, 4096
  s_add_u32 s46, s51, 28672
  buffer_load_dwordx4 v8, s[24:27], s46 offen offset:0 sc1 lds
  buffer_load_dwordx4 v8, s[24:27], s46 offen offset:1024 sc1 lds
  buffer_load_dwordx4 v8, s[24:27], s46 offen offset:2048 sc1 lds
  buffer_load_dwordx4 v8, s[24:27], s46 offen offset:3072 sc1 lds
  s_add_u32 m0, s54, 0
  s_add_u32 s46, s52, 0
  buffer_load_dwordx4 v9, s[28:31], s46 offen lds
  s_add_u32 m0, s54, 1024
  s_add_u32 s46, s52, 32768
  buffer_load_dwordx4 v10, s[28:31], s46 offen lds
  s_add_u32 m0, s54, 2048
  s_add_u32 s46, s52, 65536
  buffer_load_dwordx4 v9, s[28:31], s46 offen lds
  s_add_u32 m0, s54, 3072
  s_add_u32 s46, s52, 98304
  buffer_load_dwordx4 v10, s[28:31], s46 offen lds
  s_waitcnt vmcnt(12)
  s_barrier
  s_mul_i32 s45, s55, 114688
  s_add_u32 s51, s56, s45
  s_lshl_b32 s45, s55, 7
  s_add_u32 s52, s57, s45
  s_add_u32 s55, s55, 1
  s_and_b32 s55, s55, 31
  s_add_u32 m0, s53, 16384
  s_add_u32 s46, s51, 0
  buffer_load_dwordx4 v8, s[24:27], s46 offen offset:0 sc1 lds
  buffer_load_dwordx4 v8, s[24:27], s46 offen offset:1024 sc1 lds
  buffer_load_dwordx4 v8, s[24:27], s46 offen offset:2048 sc1 lds
  buffer_load_dwordx4 v8, s[24:27], s46 offen offset:3072 sc1 lds
  s_add_u32 m0, s53, 20480
  s_add_u32 s46, s51, 28672
  buffer_load_dwordx4 v8, s[24:27], s46 offen offset:0 sc1 lds
  buffer_load_dwordx4 v8, s[24:27], s46 offen offset:1024 sc1 lds
  buffer_load_dwordx4 v8, s[24:27], s46 offen offset:2048 sc1 lds
  buffer_load_dwordx4 v8, s[24:27], s46 offen offset:3072 sc1 lds
  s_add_u32 m0, s54, 8192
  s_add_u32 s46, s52, 0
  buffer_load_dwordx4 v9, s[28:31], s46 offen lds
  s_add_u32 m0, s54, 9216
  s_add_u32 s46, s52, 32768
  buffer_load_dwordx4 v10, s[28:31], s46 offen lds
  s_add_u32 m0, s54, 10240
  s_add_u32 s46, s52, 65536
  buffer_load_dwordx4 v9, s[28:31], s46 offen lds
  s_add_u32 m0, s54, 11264
  s_add_u32 s46, s52, 98304
  buffer_load_dwordx4 v10, s[28:31], s46 offen lds
  s_cmp_lg_u32 s48, 4
  s_cbranch_scc1 L_sp_py0
  buffer_load_dword v16, v17, s[24:27], s47 offen sc1
L_sp_py0:
  s_cmp_lg_u32 s48, 5
  s_cbranch_scc1 L_sp_pys
  v_cmp_ne_u32 vcc, s4, v16
  s_mov_b32 s62, s48
  s_cbranch_vccz L_sp_pys
L_sp_py:
  buffer_load_dword v16, v17, s[24:27], s47 offen sc1
  s_waitcnt vmcnt(0)
  v_cmp_ne_u32 vcc, s4, v16
  s_add_u32 s48, s48, 1
  s_cbranch_vccz L_sp_pyd
  s_cmp_gt_u32 s48, 0x200000
  s_cbranch_scc1 L_sp_pyd
  s_sleep 2
  s_branch L_sp_py
L_sp_pyd:
  s_mov_b32 s48, s62
L_sp_pys:
  s_add_u32 s48, s48, 1
  s_cmp_lt_u32 s48, 10
  s_cbranch_scc1 L_sp_lloop
  s_waitcnt vmcnt(12)
  s_barrier
  s_waitcnt vmcnt(0)
  s_barrier
  s_barrier
  s_branch L_sp_ly0
L_sp_lsp:
  s_barrier
L_sp_ly0:
  s_lshl_b32 s44, s41, 2
  s_lshl_b32 s45, s58, 1
  s_add_u32 s55, s44, s45
  s_mul_i32 s59, s55, 28672
  s_add_u32 s59, s59, 25165824
  s_lshl_b32 s60, s58, 15
  s_lshl_b32 s44, s42, 7
  s_add_u32 s60, s60, s44
  s_lshl_b32 s61, s58, 12
  s_add_u32 m0, s61, 8192
  s_add_u32 s46, s60, 0
  buffer_load_dwordx4 v11, s[32:35], s46 offen lds
  s_add_u32 m0, s61, 9216
  s_add_u32 s46, s60, 8192
  buffer_load_dwordx4 v11, s[32:35], s46 offen lds
  s_add_u32 m0, s61, 10240
  s_add_u32 s46, s60, 16384
  buffer_load_dwordx4 v11, s[32:35], s46 offen lds
  s_add_u32 m0, s61, 11264
  s_add_u32 s46, s60, 24576
  buffer_load_dwordx4 v11, s[32:35], s46 offen lds
  s_add_u32 m0, s61, 24576
  s_add_u32 s46, s60, 65536
  buffer_load_dwordx4 v11, s[32:35], s46 offen lds
  s_add_u32 m0, s61, 25600
  s_add_u32 s46, s60, 73728
  buffer_load_dwordx4 v11, s[32:35], s46 offen lds
  s_add_u32 m0, s61, 26624
  s_add_u32 s46, s60, 81920
  buffer_load_dwordx4 v11, s[32:35], s46 offen lds
  s_add_u32 m0, s61, 27648
  s_add_u32 s46, s60, 90112
  buffer_load_dwordx4 v11, s[32:35], s46 offen lds
  s_add_u32 m0, s61, 40960
  s_add_u32 s46, s60, 131072
  buffer_load_dwordx4 v11, s[32:35], s46 offen lds
  s_add_u32 m0, s61, 41984
  s_add_u32 s46, s60, 139264
  buffer_load_dwordx4 v11, s[32:35], s46 offen lds
  s_add_u32 m0, s61, 43008
  s_add_u32 s46, s60, 147456
  buffer_load_dwordx4 v11, s[32:35], s46 offen lds
  s_add_u32 m0, s61, 44032
  s_add_u32 s46, s60, 155648
  buffer_load_dwordx4 v11, s[32:35], s46 offen lds
  s_add_u32 m0, s61, 57344
  s_add_u32 s46, s60, 196608
  buffer_load_dwordx4 v11, s[32:35], s46 offen lds
  s_add_u32 m0, s61, 58368
  s_add_u32 s46, s60, 204800
  buffer_load_dwordx4 v11, s[32:35], s46 offen lds
  s_add_u32 m0, s61, 59392
  s_add_u32 s46, s60, 212992
  buffer_load_dwordx4 v11, s[32:35], s46 offen lds
  s_add_u32 m0, s61, 60416
  s_add_u32 s46, s60, 221184
  buffer_load_dwordx4 v11, s[32:35], s46 offen lds
  s_add_u32 m0, s61, 73728
  s_add_u32 s46, s60, 262144
  buffer_load_dwordx4 v11, s[32:35], s46 offen lds
  s_add_u32 m0, s61, 74752
  s_add_u32 s46, s60, 270336
  buffer_load_dwordx4 v11, s[32:35], s46 offen lds
  s_add_u32 m0, s61, 75776
  s_add_u32 s46, s60, 278528
  buffer_load_dwordx4 v11, s[32:35], s46 offen lds
  s_add_u32 m0, s61, 76800
  s_add_u32 s46, s60, 286720
  buffer_load_dwordx4 v11, s[32:35], s46 offen lds
  v_min_u32 v17, 6, v1
  v_lshlrev_b32 v17, 7, v17
  s_lshl_b32 s47, s41, 10
  s_add_u32 s47, s47, 23068672
  s_mov_b32 s48, 0
  s_cmp_eq_u32 s42, 7
  s_cbranch_scc1 L_sp_ph
  s_barrier
  s_cmp_lg_u32 s58, 0
  s_cbranch_scc1 L_sp_ph
  s_lshl_b32 s44, s42, 7
  s_add_u32 s44, s44, s47
  v_mov_b32 v16, s4
  s_mov_b64 exec, 1
  buffer_store_dword v16, off, s[24:27], s44 sc1
  s_mov_b64 exec, -1
L_sp_ph:
  buffer_load_dword v16, v17, s[24:27], s47 offen sc1
  s_waitcnt vmcnt(0)
  v_cmp_ne_u32 vcc, s4, v16
  s_add_u32 s48, s48, 1
  s_cbranch_vccz L_sp_phd
  s_cmp_gt_u32 s48, 0x200000
  s_cbranch_scc1 L_sp_phd
  s_sleep 2
  s_cmp_lg_u64 vcc, exec
  s_cbranch_scc1 L_sp_ph
  s_sleep 24
  s_branch L_sp_ph
L_sp_phd:
  s_add_u32 m0, s61, 0
  s_add_u32 s46, s59, 0
  buffer_load_dwordx4 v8, s[24:27], s46 offen sc1 lds
  buffer_load_dwordx4 v8, s[24:27], s46 offen offset:1024 sc1 lds
  s_add_u32 m0, s61, 2048
  s_add_u32 s46, s59, 28672
  buffer_load_dwordx4 v8, s[24:27], s46 offen sc1 lds
  buffer_load_dwordx4 v8, s[24:27], s46 offen offset:1024 sc1 lds
  s_add_u32 m0, s61, 16384
  s_add_u32 s46, s59, 2048
  buffer_load_dwordx4 v8, s[24:27], s46 offen sc1 lds
  buffer_load_dwordx4 v8, s[24:27], s46 offen offset:1024 sc1 lds
  s_add_u32 m0, s61, 18432
  s_add_u32 s46, s59, 30720
  buffer_load_dwordx4 v8, s[24:27], s46 offen sc1 lds
  buffer_load_dwordx4 v8, s[24:27], s46 offen offset:1024 sc1 lds
  s_add_u32 m0, s61, 32768
  s_add_u32 s46, s59, 4096
  buffer_load_dwordx4 v8, s[24:27], s46 offen sc1 lds
  buffer_load_dwordx4 v8, s[24:27], s46 offen offset:1024 sc1 lds
  s_add_u32 m0, s61, 34816
  s_add_u32 s46, s59, 32768
  buffer_load_dwordx4 v8, s[24:27], s46 offen sc1 lds
  buffer_load_dwordx4 v8, s[24:27], s46 offen offset:1024 sc1 lds
  s_add_u32 m0, s61, 49152
  s_add_u32 s46, s59, 6144
  buffer_load_dwordx4 v8, s[24:27], s46 offen sc1 lds
  buffer_load_dwordx4 v8, s[24:27], s46 offen offset:1024 sc1 lds
  s_add_u32 m0, s61, 51200
  s_add_u32 s46, s59, 34816
  buffer_load_dwordx4 v8, s[24:27], s46 offen sc1 lds
  buffer_load_dwordx4 v8, s[24:27], s46 offen offset:1024 sc1 lds
  s_add_u32 m0, s61, 65536
  s_add_u32 s46, s59, 8192
  buffer_load_dwordx4 v8, s[24:27], s46 offen sc1 lds
  buffer_load_dwordx4 v8, s[24:27], s46 offen offset:1024 sc1 lds
  s_add_u32 m0, s61, 67584
  s_add_u32 s46, s59, 36864
  buffer_load_dwordx4 v8, s[24:27], s46 offen sc1 lds
  buffer_load_dwordx4 v8, s[24:27], s46 offen offset:1024 sc1 lds
  s_waitcnt vmcnt(16)
  s_barrier
  s_waitcnt vmcnt(12)
  s_barrier
  s_add_u32 m0, s61, 8192
  s_add_u32 s46, s60, 327680
  buffer_load_dwordx4 v11, s[32:35], s46 offen lds
  s_add_u32 m0, s61, 9216
  s_add_u32 s46, s60, 335872
  buffer_load_dwordx4 v11, s[32:35], s46 offen lds
  s_add_u32 m0, s61, 10240
  s_add_u32 s46, s60, 344064
  buffer_load_dwordx4 v11, s[32:35], s46 offen lds
  s_add_u32 m0, s61, 11264
  s_add_u32 s46, s60, 352256
  buffer_load_dwordx4 v11, s[32:35], s46 offen lds
  s_add_u32 m0, s61, 0
  s_add_u32 s46, s59, 10240
  buffer_load_dwordx4 v8, s[24:27], s46 offen sc1 lds
  buffer_load_dwordx4 v8, s[24:27], s46 offen offset:1024 sc1 lds
  s_add_u32 m0, s61, 2048
  s_add_u32 s46, s59, 38912
  buffer_load_dwordx4 v8, s[24:27], s46 offen sc1 lds
  buffer_load_dwordx4 v8, s[24:27], s46 offen offset:1024 sc1 lds
  s_waitcnt vmcnt(16)
  s_barrier
  s_add_u32 m0, s61, 24576
  s_add_u32 s46, s60, 393216
  buffer_load_dwordx4 v11, s[32:35], s46 offen lds
  s_add_u32 m0, s61, 25600
  s_add_u32 s46, s60, 401408
  buffer_load_dwordx4 v11, s[32:35], s46 offen lds
  s_add_u32 m0, s61, 26624
  s_add_u32 s46, s60, 409600
  buffer_load_dwordx4 v11, s[32:35], s46 offen lds
  s_add_u32 m0, s61, 27648
  s_add_u32 s46, s60, 417792
  buffer_load_dwordx4 v11, s[32:35], s46 offen lds
  s_add_u32 m0, s61, 16384
  s_add_u32 s46, s59, 12288
  buffer_load_dwordx4 v8, s[24:27], s46 offen sc1 lds
  buffer_load_dwordx4 v8, s[24:27], s46 offen offset:1024 sc1 lds
  s_add_u32 m0, s61, 18432
  s_add_u32 s46, s59, 40960
  buffer_load_dwordx4 v8, s[24:27], s46 offen sc1 lds
  buffer_load_dwordx4 v8, s[24:27], s46 offen offset:1024 sc1 lds
  s_waitcnt vmcnt(20)
  s_barrier
  s_add_u32 m0, s61, 40960
  s_add_u32 s46, s60, 458752
  buffer_load_dwordx4 v11, s[32:35], s46 offen lds
  s_add_u32 m0, s61, 41984
  s_add_u32 s46, s60, 466944
  buffer_load_dwordx4 v11, s[32:35], s46 offen lds
  s_add_u32 m0, s61, 43008
  s_add_u32 s46, s60, 475136
  buffer_load_dwordx4 v11, s[32:35], s46 offen lds
  s_add_u32 m0, s61, 44032
  s_add_u32 s46, s60, 483328
  buffer_load_dwordx4 v11, s[32:35], s46 offen lds
  s_add_u32 m0, s61, 32768
  s_add_u32 s46, s59, 14336
  buffer_load_dwordx4 v8, s[24:27], s46 offen sc1 lds
  buffer_load_dwordx4 v8, s[24:27], s46 offen offset:1024 sc1 lds
  s_add_u32 m0, s61, 34816
  s_add_u32 s46, s59, 43008
  buffer_load_dwordx4 v8, s[24:27], s46 offen sc1 lds
  buffer_load_dwordx4 v8, s[24:27], s46 offen offset:1024 sc1 lds
  s_waitcnt vmcnt(24)
  s_barrier
  s_add_u32 m0, s61, 57344
  s_add_u32 s46, s60, 524288
  buffer_load_dwordx4 v11, s[32:35], s46 offen lds
  s_add_u32 m0, s61, 58368
  s_add_u32 s46, s60, 532480
  buffer_load_dwordx4 v11, s[32:35], s46 offen lds
  s_add_u32 m0, s61, 59392
  s_add_u32 s46, s60, 540672
  buffer_load_dwordx4 v11, s[32:35], s46 offen lds
  s_add_u32 m0, s61, 60416
  s_add_u32 s46, s60, 548864
  buffer_load_dwordx4 v11, s[32:35], s46 offen lds
  s_add_u32 m0, s61, 49152
  s_add_u32 s46, s59, 16384
  buffer_load_dwordx4 v8, s[24:27], s46 offen sc1 lds
  buffer_load_dwordx4 v8, s[24:27], s46 offen offset:1024 sc1 lds
  s_add_u32 m0, s61, 51200
  s_add_u32 s46, s59, 45056
  buffer_load_dwordx4 v8, s[24:27], s46 offen sc1 lds
  buffer_load_dwordx4 v8, s[24:27], s46 offen offset:1024 sc1 lds
  s_waitcnt vmcnt(24)
  s_barrier
  s_add_u32 m0, s61, 73728
  s_add_u32 s46, s60, 589824
  buffer_load_dwordx4 v11, s[32:35], s46 offen lds
  s_add_u32 m0, s61, 74752
  s_add_u32 s46, s60, 598016
  buffer_load_dwordx4 v11, s[32:35], s46 offen lds
  s_add_u32 m0, s61, 75776
  s_add_u32 s46, s60, 606208
  buffer_load_dwordx4 v11, s[32:35], s46 offen lds
  s_add_u32 m0, s61, 76800
  s_add_u32 s46, s60, 614400
  buffer_load_dwordx4 v11, s[32:35], s46 offen lds
  s_add_u32 m0, s61, 65536
  s_add_u32 s46, s59, 18432
  buffer_load_dwordx4 v8, s[24:27], s46 offen sc1 lds
  buffer_load_dwordx4 v8, s[24:27], s46 offen offset:1024 sc1 lds
  s_add_u32 m0, s61, 67584
  s_add_u32 s46, s59, 47104
  buffer_load_dwordx4 v8, s[24:27], s46 offen sc1 lds
  buffer_load_dwordx4 v8, s[24:27], s46 offen offset:1024 sc1 lds
  s_waitcnt vmcnt(24)
  s_barrier
  s_add_u32 m0, s61, 8192
  s_add_u32 s46, s60, 655360
  buffer_load_dwordx4 v11, s[32:35], s46 offen lds
  s_add_u32 m0, s61, 9216
  s_add_u32 s46, s60, 663552
  buffer_load_dwordx4 v11, s[32:35], s46 offen lds
  s_add_u32 m0, s61, 10240
  s_add_u32 s46, s60, 671744
  buffer_load_dwordx4 v11, s[32:35], s46 offen lds
  s_add_u32 m0, s61, 11264
  s_add_u32 s46, s60, 679936
  buffer_load_dwordx4 v11, s[32:35], s46 offen lds
  s_add_u32 m0, s61, 0
  s_add_u32 s46, s59, 20480
  buffer_load_dwordx4 v8, s[24:27], s46 offen sc1 lds
  buffer_load_dwordx4 v8, s[24:27], s46 offen offset:1024 sc1 lds
  s_add_u32 m0, s61, 2048
  s_add_u32 s46, s59, 49152
  buffer_load_dwordx4 v8, s[24:27], s46 offen sc1 lds
  buffer_load_dwordx4 v8, s[24:27], s46 offen offset:1024 sc1 lds
  s_waitcnt vmcnt(24)
  s_barrier
  s_add_u32 m0, s61, 24576
  s_add_u32 s46, s60, 720896
  buffer_load_dwordx4 v11, s[32:35], s46 offen lds
  s_add_u32 m0, s61, 25600
  s_add_u32 s46, s60, 729088
  buffer_load_dwordx4 v11, s[32:35], s46 offen lds
  s_add_u32 m0, s61, 26624
  s_add_u32 s46, s60, 737280
  buffer_load_dwordx4 v11, s[32:35], s46 offen lds
  s_add_u32 m0, s61, 27648
  s_add_u32 s46, s60, 745472
  buffer_load_dwordx4 v11, s[32:35], s46 offen lds
  s_add_u32 m0, s61, 16384
  s_add_u32 s46, s59, 22528
  buffer_load_dwordx4 v8, s[24:27], s46 offen sc1 lds
  buffer_load_dwordx4 v8, s[24:27], s46 offen offset:1024 sc1 lds
  s_add_u32 m0, s61, 18432
  s_add_u32 s46, s59, 51200
  buffer_load_dwordx4 v8, s[24:27], s46 offen sc1 lds
  buffer_load_dwordx4 v8, s[24:27], s46 offen offset:1024 sc1 lds
  s_waitcnt vmcnt(24)
  s_barrier
  s_add_u32 m0, s61, 40960
  s_add_u32 s46, s60, 786432
  buffer_load_dwordx4 v11, s[32:35], s46 offen lds
  s_add_u32 m0, s61, 41984
  s_add_u32 s46, s60, 794624
  buffer_load_dwordx4 v11, s[32:35], s46 offen lds
  s_add_u32 m0, s61, 43008
  s_add_u32 s46, s60, 802816
  buffer_load_dwordx4 v11, s[32:35], s46 offen lds
  s_add_u32 m0, s61, 44032
  s_add_u32 s46, s60, 811008
  buffer_load_dwordx4 v11, s[32:35], s46 offen lds
  s_add_u32 m0, s61, 32768
  s_add_u32 s46, s59, 24576
  buffer_load_dwordx4 v8, s[24:27], s46 offen sc1 lds
  buffer_load_dwordx4 v8, s[24:27], s46 offen offset:1024 sc1 lds
  s_add_u32 m0, s61, 34816
  s_add_u32 s46, s59, 53248
  buffer_load_dwordx4 v8, s[24:27], s46 offen sc1 lds
  buffer_load_dwordx4 v8, s[24:27], s46 offen offset:1024 sc1 lds
  s_waitcnt vmcnt(24)
  s_barrier
  s_add_u32 m0, s61, 57344
  s_add_u32 s46, s60, 851968
  buffer_load_dwordx4 v11, s[32:35], s46 offen lds
  s_add_u32 m0, s61, 58368
  s_add_u32 s46, s60, 860160
  buffer_load_dwordx4 v11, s[32:35], s46 offen lds
  s_add_u32 m0, s61, 59392
  s_add_u32 s46, s60, 868352
  buffer_load_dwordx4 v11, s[32:35], s46 offen lds
  s_add_u32 m0, s61, 60416
  s_add_u32 s46, s60, 876544
  buffer_load_dwordx4 v11, s[32:35], s46 offen lds
  s_add_u32 m0, s61, 49152
  s_add_u32 s46, s59, 26624
  buffer_load_dwordx4 v8, s[24:27], s46 offen sc1 lds
  buffer_load_dwordx4 v8, s[24:27], s46 offen offset:1024 sc1 lds
  s_add_u32 m0, s61, 51200
  s_add_u32 s46, s59, 55296
  buffer_load_dwordx4 v8, s[24:27], s46 offen sc1 lds
  buffer_load_dwordx4 v8, s[24:27], s46 offen offset:1024 sc1 lds
  s_waitcnt vmcnt(24)
  s_barrier
  s_add_u32 m0, s61, 73728
  s_add_u32 s46, s60, 0
  buffer_load_dwordx4 v11, s[36:39], s46 offen lds
  s_add_u32 m0, s61, 74752
  s_add_u32 s46, s60, 8192
  buffer_load_dwordx4 v11, s[36:39], s46 offen lds
  s_add_u32 m0, s61, 75776
  s_add_u32 s46, s60, 16384
  buffer_load_dwordx4 v11, s[36:39], s46 offen lds
  s_add_u32 m0, s61, 76800
  s_add_u32 s46, s60, 24576
  buffer_load_dwordx4 v11, s[36:39], s46 offen lds
  s_waitcnt vmcnt(20)
  s_barrier
  s_add_u32 m0, s61, 8192
  s_add_u32 s46, s60, 65536
  buffer_load_dwordx4 v11, s[36:39], s46 offen lds
  s_add_u32 m0, s61, 9216
  s_add_u32 s46, s60, 73728
  buffer_load_dwordx4 v11, s[36:39], s46 offen lds
  s_add_u32 m0, s61, 10240
  s_add_u32 s46, s60, 81920
  buffer_load_dwordx4 v11, s[36:39], s46 offen lds
  s_add_u32 m0, s61, 11264
  s_add_u32 s46, s60, 90112
  buffer_load_dwordx4 v11, s[36:39], s46 offen lds
  s_waitcnt vmcnt(16)
  s_barrier
  s_add_u32 m0, s61, 24576
  s_add_u32 s46, s60, 131072
  buffer_load_dwordx4 v11, s[36:39], s46 offen lds
  s_add_u32 m0, s61, 25600
  s_add_u32 s46, s60, 139264
  buffer_load_dwordx4 v11, s[36:39], s46 offen lds
  s_add_u32 m0, s61, 26624
  s_add_u32 s46, s60, 147456
  buffer_load_dwordx4 v11, s[36:39], s46 offen lds
  s_add_u32 m0, s61, 27648
  s_add_u32 s46, s60, 155648
  buffer_load_dwordx4 v11, s[36:39], s46 offen lds
  s_waitcnt vmcnt(12)
  s_barrier
  s_add_u32 m0, s61, 40960
  s_add_u32 s46, s60, 196608
  buffer_load_dwordx4 v11, s[36:39], s46 offen lds
  s_add_u32 m0, s61, 41984
  s_add_u32 s46, s60, 204800
  buffer_load_dwordx4 v11, s[36:39], s46 offen lds
  s_add_u32 m0, s61, 43008
  s_add_u32 s46, s60, 212992
  buffer_load_dwordx4 v11, s[36:39], s46 offen lds
  s_add_u32 m0, s61, 44032
  s_add_u32 s46, s60, 221184
  buffer_load_dwordx4 v11, s[36:39], s46 offen lds
  v_and_b32 v17, 31, v1
  v_lshlrev_b32 v17, 7, v17
  s_lshr_b32 s47, s41, 2
  s_lshl_b32 s47, s47, 12
  s_add_u32 s47, s47, 23101440
  s_lshl_b32 s59, s55, 14
  s_add_u32 s59, s59, 14680064
L_sp_po:
  buffer_load_dword v16, v17, s[24:27], s47 offen sc1
  s_waitcnt vmcnt(0)
  v_cmp_ne_u32 vcc, s4, v16
  s_add_u32 s48, s48, 1
  s_cbranch_vccz L_sp_pod
  s_cmp_gt_u32 s48, 0x200000
  s_cbranch_scc1 L_sp_pod
  s_sleep 1
  s_cmp_lg_u64 vcc, exec
  s_cbranch_scc1 L_sp_po
  s_sleep 24
  s_branch L_sp_po
L_sp_pod:
  s_add_u32 m0, s61, 65536
  s_add_u32 s46, s59, 0
  buffer_load_dwordx4 v8, s[24:27], s46 offen sc1 lds
  buffer_load_dwordx4 v8, s[24:27], s46 offen offset:1024 sc1 lds
  s_add_u32 m0, s61, 67584
  s_add_u32 s46, s59, 16384
  buffer_load_dwordx4 v8, s[24:27], s46 offen sc1 lds
  buffer_load_dwordx4 v8, s[24:27], s46 offen offset:1024 sc1 lds
  s_add_u32 m0, s61, 0
  s_add_u32 s46, s59, 2048
  buffer_load_dwordx4 v8, s[24:27], s46 offen sc1 lds
  buffer_load_dwordx4 v8, s[24:27], s46 offen offset:1024 sc1 lds
  s_add_u32 m0, s61, 2048
  s_add_u32 s46, s59, 18432
  buffer_load_dwordx4 v8, s[24:27], s46 offen sc1 lds
  buffer_load_dwordx4 v8, s[24:27], s46 offen offset:1024 sc1 lds
  s_add_u32 m0, s61, 16384
  s_add_u32 s46, s59, 4096
  buffer_load_dwordx4 v8, s[24:27], s46 offen sc1 lds
  buffer_load_dwordx4 v8, s[24:27], s46 offen offset:1024 sc1 lds
  s_add_u32 m0, s61, 18432
  s_add_u32 s46, s59, 20480
  buffer_load_dwordx4 v8, s[24:27], s46 offen sc1 lds
  buffer_load_dwordx4 v8, s[24:27], s46 offen offset:1024 sc1 lds
  s_add_u32 m0, s61, 32768
  s_add_u32 s46, s59, 6144
  buffer_load_dwordx4 v8, s[24:27], s46 offen sc1 lds
  buffer_load_dwordx4 v8, s[24:27], s46 offen offset:1024 sc1 lds
  s_add_u32 m0, s61, 34816
  s_add_u32 s46, s59, 22528
  buffer_load_dwordx4 v8, s[24:27], s46 offen sc1 lds
  buffer_load_dwordx4 v8, s[24:27], s46 offen offset:1024 sc1 lds
  s_waitcnt vmcnt(12)
  s_barrier
  s_add_u32 m0, s61, 57344
  s_add_u32 s46, s60, 262144
  buffer_load_dwordx4 v11, s[36:39], s46 offen lds
  s_add_u32 m0, s61, 58368
  s_add_u32 s46, s60, 270336
  buffer_load_dwordx4 v11, s[36:39], s46 offen lds
  s_add_u32 m0, s61, 59392
  s_add_u32 s46, s60, 278528
  buffer_load_dwordx4 v11, s[36:39], s46 offen lds
  s_add_u32 m0, s61, 60416
  s_add_u32 s46, s60, 286720
  buffer_load_dwordx4 v11, s[36:39], s46 offen lds
  s_add_u32 m0, s61, 49152
  s_add_u32 s46, s59, 8192
  buffer_load_dwordx4 v8, s[24:27], s46 offen sc1 lds
  buffer_load_dwordx4 v8, s[24:27], s46 offen offset:1024 sc1 lds
  s_add_u32 m0, s61, 51200
  s_add_u32 s46, s59, 24576
  buffer_load_dwordx4 v8, s[24:27], s46 offen sc1 lds
  buffer_load_dwordx4 v8, s[24:27], s46 offen offset:1024 sc1 lds
  s_waitcnt vmcnt(16)
  s_barrier
  s_add_u32 m0, s61, 73728
  s_add_u32 s46, s60, 327680
  buffer_load_dwordx4 v11, s[36:39], s46 offen lds
  s_add_u32 m0, s61, 74752
  s_add_u32 s46, s60, 335872
  buffer_load_dwordx4 v11, s[36:39], s46 offen lds
  s_add_u32 m0, s61, 75776
  s_add_u32 s46, s60, 344064
  buffer_load_dwordx4 v11, s[36:39], s46 offen lds
  s_add_u32 m0, s61, 76800
  s_add_u32 s46, s60, 352256
  buffer_load_dwordx4 v11, s[36:39], s46 offen lds
  s_add_u32 m0, s61, 65536
  s_add_u32 s46, s59, 10240
  buffer_load_dwordx4 v8, s[24:27], s46 offen sc1 lds
  buffer_load_dwordx4 v8, s[24:27], s46 offen offset:1024 sc1 lds
  s_add_u32 m0, s61, 67584
  s_add_u32 s46, s59, 26624
  buffer_load_dwordx4 v8, s[24:27], s46 offen sc1 lds
  buffer_load_dwordx4 v8, s[24:27], s46 offen offset:1024 sc1 lds
  s_waitcnt vmcnt(20)
  s_barrier
  s_add_u32 m0, s61, 8192
  s_add_u32 s46, s60, 393216
  buffer_load_dwordx4 v11, s[36:39], s46 offen lds
  s_add_u32 m0, s61, 9216
  s_add_u32 s46, s60, 401408
  buffer_load_dwordx4 v11, s[36:39], s46 offen lds
  s_add_u32 m0, s61, 10240
  s_add_u32 s46, s60, 409600
  buffer_load_dwordx4 v11, s[36:39], s46 offen lds
  s_add_u32 m0, s61, 11264
  s_add_u32 s46, s60, 417792
  buffer_load_dwordx4 v11, s[36:39], s46 offen lds
  s_add_u32 m0, s61, 0
  s_add_u32 s46, s59, 12288
  buffer_load_dwordx4 v8, s[24:27], s46 offen sc1 lds
  buffer_load_dwordx4 v8, s[24:27], s46 offen offset:1024 sc1 lds
  s_add_u32 m0, s61, 2048
  s_add_u32 s46, s59, 28672
  buffer_load_dwordx4 v8, s[24:27], s46 offen sc1 lds
  buffer_load_dwordx4 v8, s[24:27], s46 offen offset:1024 sc1 lds
  s_waitcnt vmcnt(24)
  s_barrier
  s_add_u32 m0, s61, 24576
  s_add_u32 s46, s60, 458752
  buffer_load_dwordx4 v11, s[36:39], s46 offen lds
  s_add_u32 m0, s61, 25600
  s_add_u32 s46, s60, 466944
  buffer_load_dwordx4 v11, s[36:39], s46 offen lds
  s_add_u32 m0, s61, 26624
  s_add_u32 s46, s60, 475136
  buffer_load_dwordx4 v11, s[36:39], s46 offen lds
  s_add_u32 m0, s61, 27648
  s_add_u32 s46, s60, 483328
  buffer_load_dwordx4 v11, s[36:39], s46 offen lds
  s_add_u32 m0, s61, 16384
  s_add_u32 s46, s59, 14336
  buffer_load_dwordx4 v8, s[24:27], s46 offen sc1 lds
  buffer_load_dwordx4 v8, s[24:27], s46 offen offset:1024 sc1 lds
  s_add_u32 m0, s61, 18432
  s_add_u32 s46, s59, 30720
  buffer_load_dwordx4 v8, s[24:27], s46 offen sc1 lds
  buffer_load_dwordx4 v8, s[24:27], s46 offen offset:1024 sc1 lds
  s_waitcnt vmcnt(24)
  s_barrier
  s_waitcnt vmcnt(16)
  s_barrier
  s_waitcnt vmcnt(8)
  s_barrier
  s_waitcnt vmcnt(0)
  s_barrier
  s_endpgm
L_sp_pref:
  s_barrier
  s_mov_b32 s32, s12
  s_and_b32 s33, s13, 0xffff
  s_mov_b32 s34, 8388608
  s_mov_b32 s35, 0x20000
  s_mov_b32 s28, s16
  s_and_b32 s29, s17, 0xffff
  s_mov_b32 s30, 917504
  s_mov_b32 s31, 0x20000
  s_mov_b32 s36, s20
  s_and_b32 s37, s21, 0xffff
  s_mov_b32 s38, 524288
  s_mov_b32 s39, 0x20000
  s_cmp_lg_u32 s42, 7
  s_cbranch_scc1 L_sp_wend
  v_lshrrev_b32 v5, 3, v1
  v_and_b32 v4, 7, v1
  s_lshl_b32 s45, s50, 2
  v_add_u32 v4, s45, v4
  v_lshlrev_b32 v5, 12, v5
  s_lshl_b32 s46, s41, 18
  s_and_b32 s44, s40, 1
  s_lshl_b32 s45, s44, 17
  s_add_u32 s46, s46, s45
  v_lshlrev_b32 v7, 7, v1
  v_add_u32 v4, 0, v4
  v_and_b32 v6, 31, v4
  v_lshl_add_u32 v6, v6, 7, v5
  s_add_u32 s47, s46, 0
  buffer_load_dword v9, v6, s[32:35], s47 offen
  s_waitcnt vmcnt(1)
  s_add_u32 s47, s46, 32768
  buffer_load_dword v9, v6, s[32:35], s47 offen
  s_waitcnt vmcnt(1)
  s_add_u32 s47, s46, 65536
  buffer_load_dword v9, v6, s[32:35], s47 offen
  s_waitcnt vmcnt(1)
  s_add_u32 s47, s46, 98304
  buffer_load_dword v9, v6, s[32:35], s47 offen
  s_waitcnt vmcnt(1)
  v_add_u32 v4, 8, v4
  v_and_b32 v6, 31, v4
  v_lshl_add_u32 v6, v6, 7, v5
  s_add_u32 s47, s46, 0
  buffer_load_dword v9, v6, s[32:35], s47 offen
  s_waitcnt vmcnt(1)
  s_add_u32 s47, s46, 32768
  buffer_load_dword v9, v6, s[32:35], s47 offen
  s_waitcnt vmcnt(1)
  s_add_u32 s47, s46, 65536
  buffer_load_dword v9, v6, s[32:35], s47 offen
  s_waitcnt vmcnt(1)
  s_add_u32 s47, s46, 98304
  buffer_load_dword v9, v6, s[32:35], s47 offen
  s_waitcnt vmcnt(1)
  v_add_u32 v4, 8, v4
  v_and_b32 v6, 31, v4
  v_lshl_add_u32 v6, v6, 7, v5
  s_add_u32 s47, s46, 0
  buffer_load_dword v9, v6, s[32:35], s47 offen
  s_waitcnt vmcnt(1)
  s_add_u32 s47, s46, 32768
  buffer_load_dword v9, v6, s[32:35], s47 offen
  s_waitcnt vmcnt(1)
  s_add_u32 s47, s46, 65536
  buffer_load_dword v9, v6, s[32:35], s47 offen
  s_waitcnt vmcnt(1)
  s_add_u32 s47, s46, 98304
  buffer_load_dword v9, v6, s[32:35], s47 offen
  s_waitcnt vmcnt(1)
  v_add_u32 v4, 8, v4
  v_and_b32 v6, 31, v4
  v_lshl_add_u32 v6, v6, 7, v5
  s_add_u32 s47, s46, 0
  buffer_load_dword v9, v6, s[32:35], s47 offen
  s_waitcnt vmcnt(1)
  s_add_u32 s47, s46, 32768
  buffer_load_dword v9, v6, s[32:35], s47 offen
  s_waitcnt vmcnt(1)
  s_add_u32 s47, s46, 65536
  buffer_load_dword v9, v6, s[32:35], s47 offen
  s_waitcnt vmcnt(1)
  s_add_u32 s47, s46, 98304
  buffer_load_dword v9, v6, s[32:35], s47 offen
  s_waitcnt vmcnt(1)
  s_lshl_b32 s45, s41, 1
  s_add_u32 s45, s45, s44
  s_lshl_b32 s46, s45, 14
  s_add_u32 s47, s46, 8192
  buffer_load_dword v9, v7, s[28:31], s46 offen
  buffer_load_dword v9, v7, s[28:31], s47 offen
  s_lshl_b32 s46, s45, 13
  buffer_load_dword v9, v7, s[36:39], s46 offen
L_sp_wend:
  s_endpgm
  s_cmp_eq_u32 s40, 6
  s_cselect_b32 s28, s16, s20
  s_cselect_b32 s29, s17, s21
  s_cselect_b32 s45, 28, 16
  s_and_b32 s29, s29, 0xffff
  s_lshl_b32 s30, s45, 15
  s_mov_b32 s31, 0x20000
  v_min_u32 v4, s45, v1
  v_lshlrev_b32 v4, 7, v4
  s_mul_i32 s46, s45, s3
  s_lshl_b32 s46, s46, 7
  buffer_load_dword v8, v4, s[28:31], s46 offen
  s_endpgm
L_exit:
  s_endpgm
.section .rodata,"a"
.p2align 6
.amdhsa_kernel recurrent_scan__softmax_full_mha__mixer_gmlp__prompt_kernel
  .amdhsa_next_free_vgpr 124
  .amdhsa_next_free_sgpr 63
  .amdhsa_accum_offset 124
  .amdhsa_group_segment_fixed_size 0
  .amdhsa_kernarg_size 88
  .amdhsa_user_sgpr_count 2
  .amdhsa_user_sgpr_kernarg_segment_ptr 1
  .amdhsa_system_sgpr_workgroup_id_x 1
.end_amdhsa_kernel
```
